```python
import torch

def _softmax(x, axis=-1):
    return torch.softmax(x, dim=axis)
def _gelu(x):
    return torch.nn.functional.gelu(x, approximate="tanh")
def _silu(x):
    return torch.nn.functional.silu(x)
def _sigmoid(x):
    return torch.sigmoid(x)
def _layernorm(x, axis=-1, eps=1e-5):
    m = x.mean(dim=axis, keepdim=True)
    v = x.var(dim=axis, keepdim=True, unbiased=False)
    return (x - m) / torch.sqrt(v + eps)
def _scatter_add(tgt, idx, src, axis=0):
    return tgt.clone().index_add_(axis, idx, src)
def _segment_sum(src, seg, n):
    out = torch.zeros((n,) + src.shape[1:], dtype=src.dtype)
    return out.index_add_(0, seg, src)
def _pad(x, pw):
    flat = tuple(v for pair in reversed(pw) for v in pair)
    return torch.nn.functional.pad(x, flat)

kernel_name = 'recurrent_scan__gqa_block_cached__mixer_channel_mlp__prompt'

def setup_inputs():

    _w = (lambda a: (lambda t: t.to(torch.bfloat16) if t.is_floating_point() else t)(torch.as_tensor(a)))
    def _A_setup():
        B, Sq, D = 1, 2048, 640
        Hq, Hkv, Sk, Dh = 32, 32, 2048, 192
        assert Hq % Hkv == 0, (Hq, Hkv)
        return {
            "x": _w((lambda *s: torch.randn(*s, dtype=torch.bfloat16) * 0.05)(B, Sq, D)),
            "k_cache": _w((lambda *s: torch.randn(*s, dtype=torch.bfloat16) * 1.6)(B, Hkv, Sk, Dh)),
            "v_cache": _w((lambda *s: torch.randn(*s, dtype=torch.bfloat16) * 0.8)(B, Hkv, Sk, Dh)),
            "wq": _w((lambda *s: torch.randn(*s, dtype=torch.bfloat16) * 1.6)(D, Hq * Dh) * (D ** -0.5)),
            "wo": _w((lambda *s: torch.randn(*s, dtype=torch.bfloat16) * 0.8)(Hq * Dh, D) * ((Hq * Dh) ** -0.5)),
        }
    _A_in = _A_setup()

    def _B_setup():
        B, S, D, F = 1, 2048, 640, 1536
        return {
            "x": _w((lambda *s: torch.randn(*s, dtype=torch.bfloat16) * 0.05)(B, S, D)),
            "w1": _w((lambda *s: torch.randn(*s, dtype=torch.bfloat16) * 3.2)(D, F) * (D ** -0.5)),
            "b1": _w((lambda *s: torch.randn(*s, dtype=torch.bfloat16) * 1.6)(F)),
            "w2": _w((lambda *s: torch.randn(*s, dtype=torch.bfloat16) * 0.2)(F, D) * (F ** -0.5)),
            "b2": _w((lambda *s: torch.randn(*s, dtype=torch.bfloat16) * 0.2)(D)),
        }
    _B_in = _B_setup()

    return {
        "A_x": _A_in["x"],
        "A_k_cache": _A_in["k_cache"],
        "A_v_cache": _A_in["v_cache"],
        "A_wq": _A_in["wq"],
        "A_wo": _A_in["wo"],
        "B_x": _B_in["x"],
        "B_w1": _B_in["w1"],
        "B_b1": _B_in["b1"],
        "B_w2": _B_in["w2"],
        "B_b2": _B_in["b2"],
    }

def reference(A_x, A_k_cache, A_v_cache, A_wq, A_wo, B_x, B_w1, B_b1, B_w2, B_b2):
    def _A_ref(x, k_cache, v_cache, wq, wo):
        B, Sq, D = x.shape
        Hq, Dh = 32, 192
        Hkv = k_cache.shape[1]
        rep = Hq // Hkv
        q = (lambda x, *d: x.permute(*d))((x @ wq).reshape(B, Sq, Hq, Dh), 0, 2, 1, 3)
        k = (lambda x, n, axis: torch.repeat_interleave(x, n, dim=axis))(k_cache, rep, axis=1)
        v = (lambda x, n, axis: torch.repeat_interleave(x, n, dim=axis))(v_cache, rep, axis=1)
        scores = torch.einsum("bhqd,bhkd->bhqk", q, k) * (Dh ** -0.5)
        p = _softmax(scores, axis=-1)
        o = torch.einsum("bhqk,bhkd->bhqd", p, v)
        return (lambda x, *d: x.permute(*d))(o, 0, 2, 1, 3).reshape(B, Sq, Hq * Dh) @ wo

    def _B_ref(x, w1, b1, w2, b2):
        y = _layernorm(x, axis=-1)
        h = _gelu(torch.einsum("bsd,df->bsf", y, w1) + b1)
        return torch.einsum("bsf,fd->bsd", h, w2) + b2

    x = A_x
    xn = _layernorm(x, axis=-1)
    s = _A_ref(xn, A_k_cache, A_v_cache, A_wq, A_wo)
    g = _silu(_B_ref(xn, B_w1, B_b1, B_w2, B_b2))
    return x + s * g
```

```asm
; @launch kernel=ln_kernel grid=(512,1,1) block=(256,1,1) lds=0
; @launch kernel=gemm1_kernel grid=(480,1,1) block=(512,1,1) lds=147456
; @launch kernel=attn_kernel grid=(256,1,1) block=(512,1,1) lds=98304
; @launch kernel=gemm2_kernel grid=(240,1,1) block=(512,1,1) lds=147456
; @launch kernel=final_kernel grid=(1280,1,1) block=(256,1,1) lds=0
.amdgcn_target "amdgcn-amd-amdhsa--gfx950"
.text
.globl ln_kernel
.p2align 8
.type ln_kernel,@function
ln_kernel:
    s_cmp_ge_u32 s2, 512
    s_cbranch_scc1 L_ln_end
    s_load_dwordx2 s[4:5], s[0:1], 0
    s_load_dwordx2 s[6:7], s[0:1], 96
    s_waitcnt lgkmcnt(0)
    s_mov_b32 s8, s4
    s_mov_b32 s9, s5
    s_mov_b32 s10, 2621440
    s_mov_b32 s11, 0x20000
    s_mov_b32 s12, s6
    s_mov_b32 s13, s7
    s_mov_b32 s14, 2621440
    s_mov_b32 s15, 0x20000
    s_add_u32 s16, s6, 4194304
    s_addc_u32 s17, s7, 0
    s_mov_b32 s18, 2621440
    s_mov_b32 s19, 0x20000
    s_mov_b32 s20, 0x3acccccd
    s_mov_b32 s21, 0x3727c5ac
    v_lshrrev_b32 v1, 6, v0
    v_and_b32 v2, 63, v0
    s_lshl_b32 s3, s2, 2
    v_add_u32 v1, s3, v1
    s_movk_i32 s22, 1280
    v_mul_lo_u32 v1, v1, s22
    v_lshl_add_u32 v1, v2, 2, v1
    buffer_load_dword v10, v1, s[8:11], 0 offen offset:0
    buffer_load_dword v11, v1, s[8:11], 0 offen offset:256
    buffer_load_dword v12, v1, s[8:11], 0 offen offset:512
    buffer_load_dword v13, v1, s[8:11], 0 offen offset:768
    buffer_load_dword v14, v1, s[8:11], 0 offen offset:1024
    s_waitcnt vmcnt(0)
    v_lshlrev_b32 v20, 16, v10
    v_and_b32 v21, 0xffff0000, v10
    v_lshlrev_b32 v22, 16, v11
    v_and_b32 v23, 0xffff0000, v11
    v_lshlrev_b32 v24, 16, v12
    v_and_b32 v25, 0xffff0000, v12
    v_lshlrev_b32 v26, 16, v13
    v_and_b32 v27, 0xffff0000, v13
    v_lshlrev_b32 v28, 16, v14
    v_and_b32 v29, 0xffff0000, v14
    v_add_f32 v40, v20, v21
    v_add_f32 v40, v40, v22
    v_add_f32 v40, v40, v23
    v_add_f32 v40, v40, v24
    v_add_f32 v40, v40, v25
    v_add_f32 v40, v40, v26
    v_add_f32 v40, v40, v27
    v_add_f32 v40, v40, v28
    v_add_f32 v40, v40, v29
    ds_swizzle_b32 v41, v40 offset:1055
    s_waitcnt lgkmcnt(0)
    v_add_f32 v40, v40, v41
    ds_swizzle_b32 v41, v40 offset:2079
    s_waitcnt lgkmcnt(0)
    v_add_f32 v40, v40, v41
    ds_swizzle_b32 v41, v40 offset:4127
    s_waitcnt lgkmcnt(0)
    v_add_f32 v40, v40, v41
    ds_swizzle_b32 v41, v40 offset:8223
    s_waitcnt lgkmcnt(0)
    v_add_f32 v40, v40, v41
    ds_swizzle_b32 v41, v40 offset:16415
    s_waitcnt lgkmcnt(0)
    v_add_f32 v40, v40, v41
    v_mov_b32 v41, v40
    s_nop 1
    v_permlane32_swap_b32 v40, v41
    s_nop 1
    v_add_f32 v40, v40, v41
    v_mul_f32 v42, s20, v40
    v_sub_f32 v44, v20, v42
    v_sub_f32 v45, v21, v42
    v_sub_f32 v46, v22, v42
    v_sub_f32 v47, v23, v42
    v_sub_f32 v48, v24, v42
    v_sub_f32 v49, v25, v42
    v_sub_f32 v50, v26, v42
    v_sub_f32 v51, v27, v42
    v_sub_f32 v52, v28, v42
    v_sub_f32 v53, v29, v42
    v_mul_f32 v43, v44, v44
    v_fmac_f32 v43, v45, v45
    v_fmac_f32 v43, v46, v46
    v_fmac_f32 v43, v47, v47
    v_fmac_f32 v43, v48, v48
    v_fmac_f32 v43, v49, v49
    v_fmac_f32 v43, v50, v50
    v_fmac_f32 v43, v51, v51
    v_fmac_f32 v43, v52, v52
    v_fmac_f32 v43, v53, v53
    ds_swizzle_b32 v41, v43 offset:1055
    s_waitcnt lgkmcnt(0)
    v_add_f32 v43, v43, v41
    ds_swizzle_b32 v41, v43 offset:2079
    s_waitcnt lgkmcnt(0)
    v_add_f32 v43, v43, v41
    ds_swizzle_b32 v41, v43 offset:4127
    s_waitcnt lgkmcnt(0)
    v_add_f32 v43, v43, v41
    ds_swizzle_b32 v41, v43 offset:8223
    s_waitcnt lgkmcnt(0)
    v_add_f32 v43, v43, v41
    ds_swizzle_b32 v41, v43 offset:16415
    s_waitcnt lgkmcnt(0)
    v_add_f32 v43, v43, v41
    v_mov_b32 v41, v43
    s_nop 1
    v_permlane32_swap_b32 v43, v41
    s_nop 1
    v_add_f32 v43, v43, v41
    v_mul_f32 v43, s20, v43
    v_cvt_pk_bf16_f32 v42, v42, v42
    v_lshlrev_b32 v42, 16, v42
    v_cvt_pk_bf16_f32 v43, v43, v43
    v_lshlrev_b32 v43, 16, v43
    v_add_f32 v43, s21, v43
    v_cvt_pk_bf16_f32 v43, v43, v43
    v_lshlrev_b32 v43, 16, v43
    v_sqrt_f32 v43, v43
    s_nop 0
    v_cvt_pk_bf16_f32 v43, v43, v43
    v_lshlrev_b32 v43, 16, v43
    v_rcp_f32 v43, v43
    v_sub_f32 v20, v20, v42
    v_cvt_pk_bf16_f32 v20, v20, v20
    v_lshlrev_b32 v20, 16, v20
    v_mul_f32 v20, v20, v43
    v_cvt_pk_bf16_f32 v20, v20, v20
    v_lshlrev_b32 v20, 16, v20
    v_sub_f32 v21, v21, v42
    v_cvt_pk_bf16_f32 v21, v21, v21
    v_lshlrev_b32 v21, 16, v21
    v_mul_f32 v21, v21, v43
    v_cvt_pk_bf16_f32 v21, v21, v21
    v_lshlrev_b32 v21, 16, v21
    v_sub_f32 v22, v22, v42
    v_cvt_pk_bf16_f32 v22, v22, v22
    v_lshlrev_b32 v22, 16, v22
    v_mul_f32 v22, v22, v43
    v_cvt_pk_bf16_f32 v22, v22, v22
    v_lshlrev_b32 v22, 16, v22
    v_sub_f32 v23, v23, v42
    v_cvt_pk_bf16_f32 v23, v23, v23
    v_lshlrev_b32 v23, 16, v23
    v_mul_f32 v23, v23, v43
    v_cvt_pk_bf16_f32 v23, v23, v23
    v_lshlrev_b32 v23, 16, v23
    v_sub_f32 v24, v24, v42
    v_cvt_pk_bf16_f32 v24, v24, v24
    v_lshlrev_b32 v24, 16, v24
    v_mul_f32 v24, v24, v43
    v_cvt_pk_bf16_f32 v24, v24, v24
    v_lshlrev_b32 v24, 16, v24
    v_sub_f32 v25, v25, v42
    v_cvt_pk_bf16_f32 v25, v25, v25
    v_lshlrev_b32 v25, 16, v25
    v_mul_f32 v25, v25, v43
    v_cvt_pk_bf16_f32 v25, v25, v25
    v_lshlrev_b32 v25, 16, v25
    v_sub_f32 v26, v26, v42
    v_cvt_pk_bf16_f32 v26, v26, v26
    v_lshlrev_b32 v26, 16, v26
    v_mul_f32 v26, v26, v43
    v_cvt_pk_bf16_f32 v26, v26, v26
    v_lshlrev_b32 v26, 16, v26
    v_sub_f32 v27, v27, v42
    v_cvt_pk_bf16_f32 v27, v27, v27
    v_lshlrev_b32 v27, 16, v27
    v_mul_f32 v27, v27, v43
    v_cvt_pk_bf16_f32 v27, v27, v27
    v_lshlrev_b32 v27, 16, v27
    v_sub_f32 v28, v28, v42
    v_cvt_pk_bf16_f32 v28, v28, v28
    v_lshlrev_b32 v28, 16, v28
    v_mul_f32 v28, v28, v43
    v_cvt_pk_bf16_f32 v28, v28, v28
    v_lshlrev_b32 v28, 16, v28
    v_sub_f32 v29, v29, v42
    v_cvt_pk_bf16_f32 v29, v29, v29
    v_lshlrev_b32 v29, 16, v29
    v_mul_f32 v29, v29, v43
    v_cvt_pk_bf16_f32 v29, v29, v29
    v_lshlrev_b32 v29, 16, v29
    v_lshrrev_b32 v10, 16, v20
    v_or_b32 v10, v10, v21
    buffer_store_dword v10, v1, s[12:15], 0 offen offset:0
    v_lshrrev_b32 v11, 16, v22
    v_or_b32 v11, v11, v23
    buffer_store_dword v11, v1, s[12:15], 0 offen offset:256
    v_lshrrev_b32 v12, 16, v24
    v_or_b32 v12, v12, v25
    buffer_store_dword v12, v1, s[12:15], 0 offen offset:512
    v_lshrrev_b32 v13, 16, v26
    v_or_b32 v13, v13, v27
    buffer_store_dword v13, v1, s[12:15], 0 offen offset:768
    v_lshrrev_b32 v14, 16, v28
    v_or_b32 v14, v14, v29
    buffer_store_dword v14, v1, s[12:15], 0 offen offset:1024
    v_add_f32 v40, v20, v21
    v_add_f32 v40, v40, v22
    v_add_f32 v40, v40, v23
    v_add_f32 v40, v40, v24
    v_add_f32 v40, v40, v25
    v_add_f32 v40, v40, v26
    v_add_f32 v40, v40, v27
    v_add_f32 v40, v40, v28
    v_add_f32 v40, v40, v29
    ds_swizzle_b32 v41, v40 offset:1055
    s_waitcnt lgkmcnt(0)
    v_add_f32 v40, v40, v41
    ds_swizzle_b32 v41, v40 offset:2079
    s_waitcnt lgkmcnt(0)
    v_add_f32 v40, v40, v41
    ds_swizzle_b32 v41, v40 offset:4127
    s_waitcnt lgkmcnt(0)
    v_add_f32 v40, v40, v41
    ds_swizzle_b32 v41, v40 offset:8223
    s_waitcnt lgkmcnt(0)
    v_add_f32 v40, v40, v41
    ds_swizzle_b32 v41, v40 offset:16415
    s_waitcnt lgkmcnt(0)
    v_add_f32 v40, v40, v41
    v_mov_b32 v41, v40
    s_nop 1
    v_permlane32_swap_b32 v40, v41
    s_nop 1
    v_add_f32 v40, v40, v41
    v_mul_f32 v42, s20, v40
    v_sub_f32 v44, v20, v42
    v_sub_f32 v45, v21, v42
    v_sub_f32 v46, v22, v42
    v_sub_f32 v47, v23, v42
    v_sub_f32 v48, v24, v42
    v_sub_f32 v49, v25, v42
    v_sub_f32 v50, v26, v42
    v_sub_f32 v51, v27, v42
    v_sub_f32 v52, v28, v42
    v_sub_f32 v53, v29, v42
    v_mul_f32 v43, v44, v44
    v_fmac_f32 v43, v45, v45
    v_fmac_f32 v43, v46, v46
    v_fmac_f32 v43, v47, v47
    v_fmac_f32 v43, v48, v48
    v_fmac_f32 v43, v49, v49
    v_fmac_f32 v43, v50, v50
    v_fmac_f32 v43, v51, v51
    v_fmac_f32 v43, v52, v52
    v_fmac_f32 v43, v53, v53
    ds_swizzle_b32 v41, v43 offset:1055
    s_waitcnt lgkmcnt(0)
    v_add_f32 v43, v43, v41
    ds_swizzle_b32 v41, v43 offset:2079
    s_waitcnt lgkmcnt(0)
    v_add_f32 v43, v43, v41
    ds_swizzle_b32 v41, v43 offset:4127
    s_waitcnt lgkmcnt(0)
    v_add_f32 v43, v43, v41
    ds_swizzle_b32 v41, v43 offset:8223
    s_waitcnt lgkmcnt(0)
    v_add_f32 v43, v43, v41
    ds_swizzle_b32 v41, v43 offset:16415
    s_waitcnt lgkmcnt(0)
    v_add_f32 v43, v43, v41
    v_mov_b32 v41, v43
    s_nop 1
    v_permlane32_swap_b32 v43, v41
    s_nop 1
    v_add_f32 v43, v43, v41
    v_mul_f32 v43, s20, v43
    v_cvt_pk_bf16_f32 v42, v42, v42
    v_lshlrev_b32 v42, 16, v42
    v_cvt_pk_bf16_f32 v43, v43, v43
    v_lshlrev_b32 v43, 16, v43
    v_add_f32 v43, s21, v43
    v_cvt_pk_bf16_f32 v43, v43, v43
    v_lshlrev_b32 v43, 16, v43
    v_sqrt_f32 v43, v43
    s_nop 0
    v_cvt_pk_bf16_f32 v43, v43, v43
    v_lshlrev_b32 v43, 16, v43
    v_rcp_f32 v43, v43
    v_sub_f32 v20, v20, v42
    v_cvt_pk_bf16_f32 v20, v20, v20
    v_lshlrev_b32 v20, 16, v20
    v_mul_f32 v20, v20, v43
    v_cvt_pk_bf16_f32 v20, v20, v20
    v_lshlrev_b32 v20, 16, v20
    v_sub_f32 v21, v21, v42
    v_cvt_pk_bf16_f32 v21, v21, v21
    v_lshlrev_b32 v21, 16, v21
    v_mul_f32 v21, v21, v43
    v_cvt_pk_bf16_f32 v21, v21, v21
    v_lshlrev_b32 v21, 16, v21
    v_sub_f32 v22, v22, v42
    v_cvt_pk_bf16_f32 v22, v22, v22
    v_lshlrev_b32 v22, 16, v22
    v_mul_f32 v22, v22, v43
    v_cvt_pk_bf16_f32 v22, v22, v22
    v_lshlrev_b32 v22, 16, v22
    v_sub_f32 v23, v23, v42
    v_cvt_pk_bf16_f32 v23, v23, v23
    v_lshlrev_b32 v23, 16, v23
    v_mul_f32 v23, v23, v43
    v_cvt_pk_bf16_f32 v23, v23, v23
    v_lshlrev_b32 v23, 16, v23
    v_sub_f32 v24, v24, v42
    v_cvt_pk_bf16_f32 v24, v24, v24
    v_lshlrev_b32 v24, 16, v24
    v_mul_f32 v24, v24, v43
    v_cvt_pk_bf16_f32 v24, v24, v24
    v_lshlrev_b32 v24, 16, v24
    v_sub_f32 v25, v25, v42
    v_cvt_pk_bf16_f32 v25, v25, v25
    v_lshlrev_b32 v25, 16, v25
    v_mul_f32 v25, v25, v43
    v_cvt_pk_bf16_f32 v25, v25, v25
    v_lshlrev_b32 v25, 16, v25
    v_sub_f32 v26, v26, v42
    v_cvt_pk_bf16_f32 v26, v26, v26
    v_lshlrev_b32 v26, 16, v26
    v_mul_f32 v26, v26, v43
    v_cvt_pk_bf16_f32 v26, v26, v26
    v_lshlrev_b32 v26, 16, v26
    v_sub_f32 v27, v27, v42
    v_cvt_pk_bf16_f32 v27, v27, v27
    v_lshlrev_b32 v27, 16, v27
    v_mul_f32 v27, v27, v43
    v_cvt_pk_bf16_f32 v27, v27, v27
    v_lshlrev_b32 v27, 16, v27
    v_sub_f32 v28, v28, v42
    v_cvt_pk_bf16_f32 v28, v28, v28
    v_lshlrev_b32 v28, 16, v28
    v_mul_f32 v28, v28, v43
    v_cvt_pk_bf16_f32 v28, v28, v28
    v_lshlrev_b32 v28, 16, v28
    v_sub_f32 v29, v29, v42
    v_cvt_pk_bf16_f32 v29, v29, v29
    v_lshlrev_b32 v29, 16, v29
    v_mul_f32 v29, v29, v43
    v_cvt_pk_bf16_f32 v29, v29, v29
    v_lshlrev_b32 v29, 16, v29
    v_lshrrev_b32 v30, 16, v20
    v_or_b32 v30, v30, v21
    buffer_store_dword v30, v1, s[16:19], 0 offen offset:0
    v_lshrrev_b32 v31, 16, v22
    v_or_b32 v31, v31, v23
    buffer_store_dword v31, v1, s[16:19], 0 offen offset:256
    v_lshrrev_b32 v32, 16, v24
    v_or_b32 v32, v32, v25
    buffer_store_dword v32, v1, s[16:19], 0 offen offset:512
    v_lshrrev_b32 v33, 16, v26
    v_or_b32 v33, v33, v27
    buffer_store_dword v33, v1, s[16:19], 0 offen offset:768
    v_lshrrev_b32 v34, 16, v28
    v_or_b32 v34, v34, v29
    buffer_store_dword v34, v1, s[16:19], 0 offen offset:1024
    s_waitcnt vmcnt(0)
L_ln_end:
    s_endpgm
.globl gemm1_kernel
.p2align 8
.type gemm1_kernel,@function
gemm1_kernel:
    s_cmp_ge_u32 s2, 480
    s_cbranch_scc1 L_g1_end
    s_load_dwordx2 s[4:5], s[0:1], 24
    s_load_dwordx2 s[6:7], s[0:1], 96
    s_load_dwordx2 s[36:37], s[0:1], 48
    s_load_dwordx2 s[38:39], s[0:1], 56
    s_waitcnt lgkmcnt(0)
    s_and_b32 s33, s2, 7
    s_lshr_b32 s34, s2, 3
    s_movk_i32 s24, 1280
    s_mul_i32 s26, s33, 256*1280
    s_mov_b32 s28, 10
    s_cmp_ge_u32 s34, 48
    s_cbranch_scc1 L_g1_h
    s_mov_b32 s8, s6
    s_mov_b32 s9, s7
    s_mov_b32 s10, 2621440
    s_mov_b32 s11, 0x20000
    s_mov_b32 s12, s4
    s_mov_b32 s13, s5
    s_mov_b32 s14, 7864320
    s_mov_b32 s15, 0x20000
    s_add_u32 s16, s6, 8388608
    s_addc_u32 s17, s7, 0
    s_mov_b32 s18, 25690112
    s_mov_b32 s19, 0x20000
    s_movk_i32 s25, 12288
    s_movk_i32 s35, 12544
    s_lshl_b32 s27, s34, 8
    s_branch L_g1_go
L_g1_h:
    s_add_u32 s8, s6, 4194304
    s_addc_u32 s9, s7, 0
    s_mov_b32 s10, 2621440
    s_mov_b32 s11, 0x20000
    s_mov_b32 s12, s36
    s_mov_b32 s13, s37
    s_mov_b32 s14, 1966080
    s_mov_b32 s15, 0x20000
    s_add_u32 s16, s6, 41943040
    s_addc_u32 s17, s7, 0
    s_mov_b32 s18, 6553600
    s_mov_b32 s19, 0x20000
    s_movk_i32 s25, 3072
    s_movk_i32 s35, 3200
    s_sub_u32 s27, s34, 48
    s_lshl_b32 s27, s27, 8
L_g1_go:
    s_mov_b32 s20, s38
    s_mov_b32 s21, s39
    s_mov_b32 s22, 3072
    s_mov_b32 s23, 0x20000
    s_mov_b32 s40, s27
    v_and_b32 v1, 63, v0
    v_lshrrev_b32 v2, 6, v0
    s_nop 1
    v_readfirstlane_b32 s30, v2
    v_lshrrev_b32 v3, 3, v1
    v_lshl_add_u32 v3, v2, 3, v3
    v_lshrrev_b32 v4, 1, v3
    v_xor_b32 v4, v4, v1
    v_and_b32 v4, 7, v4
    v_mul_lo_u32 v5, v3, s24
    v_lshl_add_u32 v56, v4, 4, v5
    s_lshl_b32 s31, s24, 6
    v_add_u32 v57, s31, v56
    v_add_u32 v58, s31, v57
    v_add_u32 v59, s31, v58
    v_lshrrev_b32 v3, 4, v1
    v_lshlrev_b32 v4, 2, v3
    v_xor_b32 v4, v4, v1
    v_and_b32 v4, 15, v4
    v_lshl_add_u32 v3, v2, 2, v3
    v_mul_lo_u32 v5, v3, s25
    v_lshl_add_u32 v60, v4, 4, v5
    s_lshl_b32 s31, s25, 5
    v_add_u32 v61, s31, v60
    v_and_b32 v6, 31, v1
    v_lshrrev_b32 v7, 5, v1
    v_lshrrev_b32 v8, 1, v2
    v_lshl_add_u32 v9, v8, 6, v6
    v_lshrrev_b32 v10, 1, v6
    v_and_b32 v10, 7, v10
    v_add_u32 v11, 0, v7
    v_xor_b32 v11, v11, v10
    v_lshlrev_b32 v11, 4, v11
    v_lshl_add_u32 v48, v9, 7, v11
    v_add_u32 v11, 2, v7
    v_xor_b32 v11, v11, v10
    v_lshlrev_b32 v11, 4, v11
    v_lshl_add_u32 v49, v9, 7, v11
    v_add_u32 v11, 4, v7
    v_xor_b32 v11, v11, v10
    v_lshlrev_b32 v11, 4, v11
    v_lshl_add_u32 v50, v9, 7, v11
    v_add_u32 v11, 6, v7
    v_xor_b32 v11, v11, v10
    v_lshlrev_b32 v11, 4, v11
    v_lshl_add_u32 v51, v9, 7, v11
    v_and_b32 v11, 15, v1
    v_lshrrev_b32 v11, 2, v11
    v_lshl_add_u32 v12, v7, 3, v11
    v_and_b32 v13, 1, v2
    v_lshrrev_b32 v14, 4, v1
    v_and_b32 v14, 1, v14
    v_and_b32 v15, 3, v1
    v_lshlrev_b32 v16, 3, v13
    v_add_u32 v16, 0, v16
    v_lshl_add_u32 v16, v14, 1, v16
    v_lshrrev_b32 v17, 1, v15
    v_add_u32 v16, v16, v17
    v_lshlrev_b32 v17, 2, v11
    v_xor_b32 v16, v16, v17
    v_lshlrev_b32 v16, 4, v16
    v_and_b32 v17, 1, v15
    v_lshl_add_u32 v16, v17, 3, v16
    v_lshl_add_u32 v16, v12, 8, v16
    v_add_u32 v52, 32768, v16
    v_lshlrev_b32 v16, 3, v13
    v_add_u32 v16, 4, v16
    v_lshl_add_u32 v16, v14, 1, v16
    v_lshrrev_b32 v17, 1, v15
    v_add_u32 v16, v16, v17
    v_lshlrev_b32 v17, 2, v11
    v_xor_b32 v16, v16, v17
    v_lshlrev_b32 v16, 4, v16
    v_and_b32 v17, 1, v15
    v_lshl_add_u32 v16, v17, 3, v16
    v_lshl_add_u32 v16, v12, 8, v16
    v_add_u32 v53, 32768, v16
    v_mov_b32 v64, 0
    v_mov_b32 v65, 0
    v_mov_b32 v66, 0
    v_mov_b32 v67, 0
    v_mov_b32 v68, 0
    v_mov_b32 v69, 0
    v_mov_b32 v70, 0
    v_mov_b32 v71, 0
    v_mov_b32 v72, 0
    v_mov_b32 v73, 0
    v_mov_b32 v74, 0
    v_mov_b32 v75, 0
    v_mov_b32 v76, 0
    v_mov_b32 v77, 0
    v_mov_b32 v78, 0
    v_mov_b32 v79, 0
    v_mov_b32 v80, 0
    v_mov_b32 v81, 0
    v_mov_b32 v82, 0
    v_mov_b32 v83, 0
    v_mov_b32 v84, 0
    v_mov_b32 v85, 0
    v_mov_b32 v86, 0
    v_mov_b32 v87, 0
    v_mov_b32 v88, 0
    v_mov_b32 v89, 0
    v_mov_b32 v90, 0
    v_mov_b32 v91, 0
    v_mov_b32 v92, 0
    v_mov_b32 v93, 0
    v_mov_b32 v94, 0
    v_mov_b32 v95, 0
    v_mov_b32 v96, 0
    v_mov_b32 v97, 0
    v_mov_b32 v98, 0
    v_mov_b32 v99, 0
    v_mov_b32 v100, 0
    v_mov_b32 v101, 0
    v_mov_b32 v102, 0
    v_mov_b32 v103, 0
    v_mov_b32 v104, 0
    v_mov_b32 v105, 0
    v_mov_b32 v106, 0
    v_mov_b32 v107, 0
    v_mov_b32 v108, 0
    v_mov_b32 v109, 0
    v_mov_b32 v110, 0
    v_mov_b32 v111, 0
    v_mov_b32 v112, 0
    v_mov_b32 v113, 0
    v_mov_b32 v114, 0
    v_mov_b32 v115, 0
    v_mov_b32 v116, 0
    v_mov_b32 v117, 0
    v_mov_b32 v118, 0
    v_mov_b32 v119, 0
    v_mov_b32 v120, 0
    v_mov_b32 v121, 0
    v_mov_b32 v122, 0
    v_mov_b32 v123, 0
    v_mov_b32 v124, 0
    v_mov_b32 v125, 0
    v_mov_b32 v126, 0
    v_mov_b32 v127, 0
    s_lshl_b32 s32, s30, 10
    s_mov_b32 s44, 0
    s_mov_b32 s45, 0
    s_mov_b32 s46, -98304
    s_mov_b32 s47, 49152
    s_add_u32 m0, s32, 0
    s_nop 0
    buffer_load_dwordx4 v56, s[8:11], s26 offen lds
    s_add_u32 m0, s32, 8192
    s_nop 0
    buffer_load_dwordx4 v57, s[8:11], s26 offen lds
    s_add_u32 m0, s32, 16384
    s_nop 0
    buffer_load_dwordx4 v58, s[8:11], s26 offen lds
    s_add_u32 m0, s32, 24576
    s_nop 0
    buffer_load_dwordx4 v59, s[8:11], s26 offen lds
    s_add_u32 m0, s32, 32768
    s_nop 0
    buffer_load_dwordx4 v60, s[12:15], s27 offen lds
    s_add_u32 m0, s32, 40960
    s_nop 0
    buffer_load_dwordx4 v61, s[12:15], s27 offen lds
    s_add_u32 s26, s26, 128
    s_lshl_b32 s31, s25, 6
    s_add_u32 s27, s27, s31
    s_add_u32 s32, s32, 49152
    s_add_u32 s45, s45, 1
    s_cmp_eq_u32 s45, 3
    s_cselect_b32 s31, 147456, 0
    s_cselect_b32 s45, 0, s45
    s_sub_u32 s32, s32, s31
    s_add_u32 m0, s32, 0
    s_nop 0
    buffer_load_dwordx4 v56, s[8:11], s26 offen lds
    s_add_u32 m0, s32, 8192
    s_nop 0
    buffer_load_dwordx4 v57, s[8:11], s26 offen lds
    s_add_u32 m0, s32, 16384
    s_nop 0
    buffer_load_dwordx4 v58, s[8:11], s26 offen lds
    s_add_u32 m0, s32, 24576
    s_nop 0
    buffer_load_dwordx4 v59, s[8:11], s26 offen lds
    s_add_u32 m0, s32, 32768
    s_nop 0
    buffer_load_dwordx4 v60, s[12:15], s27 offen lds
    s_add_u32 m0, s32, 40960
    s_nop 0
    buffer_load_dwordx4 v61, s[12:15], s27 offen lds
    s_add_u32 s26, s26, 128
    s_lshl_b32 s31, s25, 6
    s_add_u32 s27, s27, s31
    s_add_u32 s32, s32, 49152
    s_add_u32 s45, s45, 1
    s_cmp_eq_u32 s45, 3
    s_cselect_b32 s31, 147456, 0
    s_cselect_b32 s45, 0, s45
    s_sub_u32 s32, s32, s31
L_g1_loop:
    s_waitcnt vmcnt(6)
    s_barrier
    s_add_u32 m0, s32, 0
    s_nop 0
    buffer_load_dwordx4 v56, s[8:11], s26 offen lds
    s_add_u32 m0, s32, 8192
    s_nop 0
    buffer_load_dwordx4 v57, s[8:11], s26 offen lds
    s_add_u32 m0, s32, 16384
    s_nop 0
    buffer_load_dwordx4 v58, s[8:11], s26 offen lds
    s_add_u32 m0, s32, 24576
    s_nop 0
    buffer_load_dwordx4 v59, s[8:11], s26 offen lds
    s_add_u32 m0, s32, 32768
    s_nop 0
    buffer_load_dwordx4 v60, s[12:15], s27 offen lds
    s_add_u32 m0, s32, 40960
    s_nop 0
    buffer_load_dwordx4 v61, s[12:15], s27 offen lds
    s_add_u32 s26, s26, 128
    s_lshl_b32 s31, s25, 6
    s_add_u32 s27, s27, s31
    s_add_u32 s32, s32, 49152
    s_add_u32 s45, s45, 1
    s_cmp_eq_u32 s45, 3
    s_cselect_b32 s31, 147456, 0
    s_cselect_b32 s45, 0, s45
    s_sub_u32 s32, s32, s31
    ds_read_b128 v[16:19], v48 offset:0
    ds_read_b128 v[20:23], v48 offset:4096
    ds_read_b64_tr_b16 v[24:25], v52 offset:0
    ds_read_b64_tr_b16 v[26:27], v52 offset:1024
    ds_read_b64_tr_b16 v[28:29], v53 offset:0
    ds_read_b64_tr_b16 v[30:31], v53 offset:1024
    ds_read_b128 v[32:35], v49 offset:0
    ds_read_b128 v[36:39], v49 offset:4096
    ds_read_b64_tr_b16 v[40:41], v52 offset:4096
    ds_read_b64_tr_b16 v[42:43], v52 offset:5120
    ds_read_b64_tr_b16 v[44:45], v53 offset:4096
    ds_read_b64_tr_b16 v[46:47], v53 offset:5120
    s_waitcnt lgkmcnt(6)
    v_mfma_f32_32x32x16_bf16 v[64:79], v[24:27], v[16:19], v[64:79]
    v_mfma_f32_32x32x16_bf16 v[80:95], v[24:27], v[20:23], v[80:95]
    v_mfma_f32_32x32x16_bf16 v[96:111], v[28:31], v[16:19], v[96:111]
    v_mfma_f32_32x32x16_bf16 v[112:127], v[28:31], v[20:23], v[112:127]
    ds_read_b128 v[16:19], v50 offset:0
    ds_read_b128 v[20:23], v50 offset:4096
    ds_read_b64_tr_b16 v[24:25], v52 offset:8192
    ds_read_b64_tr_b16 v[26:27], v52 offset:9216
    ds_read_b64_tr_b16 v[28:29], v53 offset:8192
    ds_read_b64_tr_b16 v[30:31], v53 offset:9216
    s_waitcnt lgkmcnt(6)
    v_mfma_f32_32x32x16_bf16 v[64:79], v[40:43], v[32:35], v[64:79]
    v_mfma_f32_32x32x16_bf16 v[80:95], v[40:43], v[36:39], v[80:95]
    v_mfma_f32_32x32x16_bf16 v[96:111], v[44:47], v[32:35], v[96:111]
    v_mfma_f32_32x32x16_bf16 v[112:127], v[44:47], v[36:39], v[112:127]
    ds_read_b128 v[32:35], v51 offset:0
    ds_read_b128 v[36:39], v51 offset:4096
    ds_read_b64_tr_b16 v[40:41], v52 offset:12288
    ds_read_b64_tr_b16 v[42:43], v52 offset:13312
    ds_read_b64_tr_b16 v[44:45], v53 offset:12288
    ds_read_b64_tr_b16 v[46:47], v53 offset:13312
    s_waitcnt lgkmcnt(6)
    v_mfma_f32_32x32x16_bf16 v[64:79], v[24:27], v[16:19], v[64:79]
    v_mfma_f32_32x32x16_bf16 v[80:95], v[24:27], v[20:23], v[80:95]
    v_mfma_f32_32x32x16_bf16 v[96:111], v[28:31], v[16:19], v[96:111]
    v_mfma_f32_32x32x16_bf16 v[112:127], v[28:31], v[20:23], v[112:127]
    s_waitcnt lgkmcnt(0)
    s_add_u32 s44, s44, 1
    s_cmp_eq_u32 s44, 3
    s_cselect_b32 s31, s46, s47
    s_cselect_b32 s44, 0, s44
    v_add_u32 v48, s31, v48
    v_add_u32 v49, s31, v49
    v_add_u32 v50, s31, v50
    v_add_u32 v51, s31, v51
    v_add_u32 v52, s31, v52
    v_add_u32 v53, s31, v53
    v_mfma_f32_32x32x16_bf16 v[64:79], v[40:43], v[32:35], v[64:79]
    v_mfma_f32_32x32x16_bf16 v[80:95], v[40:43], v[36:39], v[80:95]
    v_mfma_f32_32x32x16_bf16 v[96:111], v[44:47], v[32:35], v[96:111]
    v_mfma_f32_32x32x16_bf16 v[112:127], v[44:47], v[36:39], v[112:127]
    s_sub_u32 s28, s28, 1
    s_cmp_lg_u32 s28, 0
    s_cbranch_scc1 L_g1_loop
    s_waitcnt vmcnt(0)
    s_nop 15
    s_lshl_b32 s33, s33, 8
    v_add_u32 v9, s33, v9
    v_mul_lo_u32 v9, v9, s35
    v_lshlrev_b32 v10, 7, v13
    v_lshl_add_u32 v10, v7, 3, v10
    v_add_u32 v10, s40, v10
    v_add_u32 v9, v9, v10
    s_lshl_b32 s33, s35, 5
    v_add_u32 v8, s33, v9
    s_cmp_ge_u32 s34, 48
    s_cbranch_scc1 L_g1_eh
    s_barrier
    v_lshlrev_b32 v11, 13, v2
    v_lshl_add_u32 v12, v6, 7, v11
    v_lshl_add_u32 v12, v7, 3, v12
    v_cvt_pk_bf16_f32 v16, v64, v65
    v_cvt_pk_bf16_f32 v17, v66, v67
    ds_write_b64 v12, v[16:17] offset:0
    v_cvt_pk_bf16_f32 v18, v68, v69
    v_cvt_pk_bf16_f32 v19, v70, v71
    ds_write_b64 v12, v[18:19] offset:16
    v_cvt_pk_bf16_f32 v20, v72, v73
    v_cvt_pk_bf16_f32 v21, v74, v75
    ds_write_b64 v12, v[20:21] offset:32
    v_cvt_pk_bf16_f32 v22, v76, v77
    v_cvt_pk_bf16_f32 v23, v78, v79
    ds_write_b64 v12, v[22:23] offset:48
    v_cvt_pk_bf16_f32 v16, v80, v81
    v_cvt_pk_bf16_f32 v17, v82, v83
    ds_write_b64 v12, v[16:17] offset:4096
    v_cvt_pk_bf16_f32 v18, v84, v85
    v_cvt_pk_bf16_f32 v19, v86, v87
    ds_write_b64 v12, v[18:19] offset:4112
    v_cvt_pk_bf16_f32 v20, v88, v89
    v_cvt_pk_bf16_f32 v21, v90, v91
    ds_write_b64 v12, v[20:21] offset:4128
    v_cvt_pk_bf16_f32 v22, v92, v93
    v_cvt_pk_bf16_f32 v23, v94, v95
    ds_write_b64 v12, v[22:23] offset:4144
    v_cvt_pk_bf16_f32 v16, v96, v97
    v_cvt_pk_bf16_f32 v17, v98, v99
    ds_write_b64 v12, v[16:17] offset:64
    v_cvt_pk_bf16_f32 v18, v100, v101
    v_cvt_pk_bf16_f32 v19, v102, v103
    ds_write_b64 v12, v[18:19] offset:80
    v_cvt_pk_bf16_f32 v20, v104, v105
    v_cvt_pk_bf16_f32 v21, v106, v107
    ds_write_b64 v12, v[20:21] offset:96
    v_cvt_pk_bf16_f32 v22, v108, v109
    v_cvt_pk_bf16_f32 v23, v110, v111
    ds_write_b64 v12, v[22:23] offset:112
    v_cvt_pk_bf16_f32 v16, v112, v113
    v_cvt_pk_bf16_f32 v17, v114, v115
    ds_write_b64 v12, v[16:17] offset:4160
    v_cvt_pk_bf16_f32 v18, v116, v117
    v_cvt_pk_bf16_f32 v19, v118, v119
    ds_write_b64 v12, v[18:19] offset:4176
    v_cvt_pk_bf16_f32 v20, v120, v121
    v_cvt_pk_bf16_f32 v21, v122, v123
    ds_write_b64 v12, v[20:21] offset:4192
    v_cvt_pk_bf16_f32 v22, v124, v125
    v_cvt_pk_bf16_f32 v23, v126, v127
    ds_write_b64 v12, v[22:23] offset:4208
    v_lshl_add_u32 v12, v1, 4, v11
    v_lshrrev_b32 v14, 3, v1
    v_lshrrev_b32 v8, 1, v2
    v_lshl_add_u32 v14, v8, 6, v14
    s_lshr_b32 s33, s33, 5
    v_and_b32 v15, 7, v1
    v_lshlrev_b32 v15, 4, v15
    v_lshl_add_u32 v15, v13, 7, v15
    v_add_u32 v15, s40, v15
    s_and_b32 s43, s2, 7
    s_lshl_b32 s43, s43, 8
    v_add_u32 v14, s43, v14
    v_mul_lo_u32 v14, v14, s35
    v_add_u32 v14, v14, v15
    s_lshl_b32 s43, s35, 3
    s_waitcnt lgkmcnt(0)
    ds_read_b128 v[16:19], v12 offset:0
    ds_read_b128 v[20:23], v12 offset:1024
    ds_read_b128 v[24:27], v12 offset:2048
    ds_read_b128 v[28:31], v12 offset:3072
    ds_read_b128 v[32:35], v12 offset:4096
    ds_read_b128 v[36:39], v12 offset:5120
    ds_read_b128 v[40:43], v12 offset:6144
    ds_read_b128 v[44:47], v12 offset:7168
    s_waitcnt lgkmcnt(7)
    buffer_store_dwordx4 v[16:19], v14, s[16:19], 0 offen
    v_add_u32 v14, s43, v14
    s_waitcnt lgkmcnt(6)
    buffer_store_dwordx4 v[20:23], v14, s[16:19], 0 offen
    v_add_u32 v14, s43, v14
    s_waitcnt lgkmcnt(5)
    buffer_store_dwordx4 v[24:27], v14, s[16:19], 0 offen
    v_add_u32 v14, s43, v14
    s_waitcnt lgkmcnt(4)
    buffer_store_dwordx4 v[28:31], v14, s[16:19], 0 offen
    v_add_u32 v14, s43, v14
    s_waitcnt lgkmcnt(3)
    buffer_store_dwordx4 v[32:35], v14, s[16:19], 0 offen
    v_add_u32 v14, s43, v14
    s_waitcnt lgkmcnt(2)
    buffer_store_dwordx4 v[36:39], v14, s[16:19], 0 offen
    v_add_u32 v14, s43, v14
    s_waitcnt lgkmcnt(1)
    buffer_store_dwordx4 v[40:43], v14, s[16:19], 0 offen
    v_add_u32 v14, s43, v14
    s_waitcnt lgkmcnt(0)
    buffer_store_dwordx4 v[44:47], v14, s[16:19], 0 offen
    v_add_u32 v14, s43, v14
    s_branch L_g1_end
L_g1_eh:
    s_mov_b32 s41, 0x3d372713
    s_mov_b32 s42, 0xc0135761
    buffer_load_dwordx2 v[32:33], v10, s[20:23], 0 offen offset:0
    buffer_load_dwordx2 v[34:35], v10, s[20:23], 0 offen offset:16
    buffer_load_dwordx2 v[36:37], v10, s[20:23], 0 offen offset:32
    buffer_load_dwordx2 v[38:39], v10, s[20:23], 0 offen offset:48
    s_waitcnt vmcnt(0)
    v_cvt_pk_bf16_f32 v24, v64, v64
    v_lshlrev_b32 v24, 16, v24
    v_lshlrev_b32 v28, 16, v32
    v_add_f32 v24, v24, v28
    v_cvt_pk_bf16_f32 v24, v24, v24
    v_lshlrev_b32 v24, 16, v24
    v_mul_f32 v28, v24, v24
    v_fma_f32 v28, v28, s41, 1.0
    v_mul_f32 v28, v28, v24
    v_mul_f32 v28, s42, v28
    v_exp_f32 v28, v28
    s_nop 0
    v_add_f32 v28, 1.0, v28
    v_rcp_f32 v28, v28
    s_nop 0
    v_mul_f32 v24, v24, v28
    v_cvt_pk_bf16_f32 v25, v65, v65
    v_lshlrev_b32 v25, 16, v25
    v_and_b32 v28, 0xffff0000, v32
    v_add_f32 v25, v25, v28
    v_cvt_pk_bf16_f32 v25, v25, v25
    v_lshlrev_b32 v25, 16, v25
    v_mul_f32 v28, v25, v25
    v_fma_f32 v28, v28, s41, 1.0
    v_mul_f32 v28, v28, v25
    v_mul_f32 v28, s42, v28
    v_exp_f32 v28, v28
    s_nop 0
    v_add_f32 v28, 1.0, v28
    v_rcp_f32 v28, v28
    s_nop 0
    v_mul_f32 v25, v25, v28
    v_cvt_pk_bf16_f32 v26, v66, v66
    v_lshlrev_b32 v26, 16, v26
    v_lshlrev_b32 v28, 16, v33
    v_add_f32 v26, v26, v28
    v_cvt_pk_bf16_f32 v26, v26, v26
    v_lshlrev_b32 v26, 16, v26
    v_mul_f32 v28, v26, v26
    v_fma_f32 v28, v28, s41, 1.0
    v_mul_f32 v28, v28, v26
    v_mul_f32 v28, s42, v28
    v_exp_f32 v28, v28
    s_nop 0
    v_add_f32 v28, 1.0, v28
    v_rcp_f32 v28, v28
    s_nop 0
    v_mul_f32 v26, v26, v28
    v_cvt_pk_bf16_f32 v27, v67, v67
    v_lshlrev_b32 v27, 16, v27
    v_and_b32 v28, 0xffff0000, v33
    v_add_f32 v27, v27, v28
    v_cvt_pk_bf16_f32 v27, v27, v27
    v_lshlrev_b32 v27, 16, v27
    v_mul_f32 v28, v27, v27
    v_fma_f32 v28, v28, s41, 1.0
    v_mul_f32 v28, v28, v27
    v_mul_f32 v28, s42, v28
    v_exp_f32 v28, v28
    s_nop 0
    v_add_f32 v28, 1.0, v28
    v_rcp_f32 v28, v28
    s_nop 0
    v_mul_f32 v27, v27, v28
    v_cvt_pk_bf16_f32 v16, v24, v25
    v_cvt_pk_bf16_f32 v17, v26, v27
    buffer_store_dwordx2 v[16:17], v9, s[16:19], 0 offen offset:0
    s_nop 0
    v_cvt_pk_bf16_f32 v24, v68, v68
    v_lshlrev_b32 v24, 16, v24
    v_lshlrev_b32 v28, 16, v34
    v_add_f32 v24, v24, v28
    v_cvt_pk_bf16_f32 v24, v24, v24
    v_lshlrev_b32 v24, 16, v24
    v_mul_f32 v28, v24, v24
    v_fma_f32 v28, v28, s41, 1.0
    v_mul_f32 v28, v28, v24
    v_mul_f32 v28, s42, v28
    v_exp_f32 v28, v28
    s_nop 0
    v_add_f32 v28, 1.0, v28
    v_rcp_f32 v28, v28
    s_nop 0
    v_mul_f32 v24, v24, v28
    v_cvt_pk_bf16_f32 v25, v69, v69
    v_lshlrev_b32 v25, 16, v25
    v_and_b32 v28, 0xffff0000, v34
    v_add_f32 v25, v25, v28
    v_cvt_pk_bf16_f32 v25, v25, v25
    v_lshlrev_b32 v25, 16, v25
    v_mul_f32 v28, v25, v25
    v_fma_f32 v28, v28, s41, 1.0
    v_mul_f32 v28, v28, v25
    v_mul_f32 v28, s42, v28
    v_exp_f32 v28, v28
    s_nop 0
    v_add_f32 v28, 1.0, v28
    v_rcp_f32 v28, v28
    s_nop 0
    v_mul_f32 v25, v25, v28
    v_cvt_pk_bf16_f32 v26, v70, v70
    v_lshlrev_b32 v26, 16, v26
    v_lshlrev_b32 v28, 16, v35
    v_add_f32 v26, v26, v28
    v_cvt_pk_bf16_f32 v26, v26, v26
    v_lshlrev_b32 v26, 16, v26
    v_mul_f32 v28, v26, v26
    v_fma_f32 v28, v28, s41, 1.0
    v_mul_f32 v28, v28, v26
    v_mul_f32 v28, s42, v28
    v_exp_f32 v28, v28
    s_nop 0
    v_add_f32 v28, 1.0, v28
    v_rcp_f32 v28, v28
    s_nop 0
    v_mul_f32 v26, v26, v28
    v_cvt_pk_bf16_f32 v27, v71, v71
    v_lshlrev_b32 v27, 16, v27
    v_and_b32 v28, 0xffff0000, v35
    v_add_f32 v27, v27, v28
    v_cvt_pk_bf16_f32 v27, v27, v27
    v_lshlrev_b32 v27, 16, v27
    v_mul_f32 v28, v27, v27
    v_fma_f32 v28, v28, s41, 1.0
    v_mul_f32 v28, v28, v27
    v_mul_f32 v28, s42, v28
    v_exp_f32 v28, v28
    s_nop 0
    v_add_f32 v28, 1.0, v28
    v_rcp_f32 v28, v28
    s_nop 0
    v_mul_f32 v27, v27, v28
    v_cvt_pk_bf16_f32 v16, v24, v25
    v_cvt_pk_bf16_f32 v17, v26, v27
    buffer_store_dwordx2 v[16:17], v9, s[16:19], 0 offen offset:16
    s_nop 0
    v_cvt_pk_bf16_f32 v24, v72, v72
    v_lshlrev_b32 v24, 16, v24
    v_lshlrev_b32 v28, 16, v36
    v_add_f32 v24, v24, v28
    v_cvt_pk_bf16_f32 v24, v24, v24
    v_lshlrev_b32 v24, 16, v24
    v_mul_f32 v28, v24, v24
    v_fma_f32 v28, v28, s41, 1.0
    v_mul_f32 v28, v28, v24
    v_mul_f32 v28, s42, v28
    v_exp_f32 v28, v28
    s_nop 0
    v_add_f32 v28, 1.0, v28
    v_rcp_f32 v28, v28
    s_nop 0
    v_mul_f32 v24, v24, v28
    v_cvt_pk_bf16_f32 v25, v73, v73
    v_lshlrev_b32 v25, 16, v25
    v_and_b32 v28, 0xffff0000, v36
    v_add_f32 v25, v25, v28
    v_cvt_pk_bf16_f32 v25, v25, v25
    v_lshlrev_b32 v25, 16, v25
    v_mul_f32 v28, v25, v25
    v_fma_f32 v28, v28, s41, 1.0
    v_mul_f32 v28, v28, v25
    v_mul_f32 v28, s42, v28
    v_exp_f32 v28, v28
    s_nop 0
    v_add_f32 v28, 1.0, v28
    v_rcp_f32 v28, v28
    s_nop 0
    v_mul_f32 v25, v25, v28
    v_cvt_pk_bf16_f32 v26, v74, v74
    v_lshlrev_b32 v26, 16, v26
    v_lshlrev_b32 v28, 16, v37
    v_add_f32 v26, v26, v28
    v_cvt_pk_bf16_f32 v26, v26, v26
    v_lshlrev_b32 v26, 16, v26
    v_mul_f32 v28, v26, v26
    v_fma_f32 v28, v28, s41, 1.0
    v_mul_f32 v28, v28, v26
    v_mul_f32 v28, s42, v28
    v_exp_f32 v28, v28
    s_nop 0
    v_add_f32 v28, 1.0, v28
    v_rcp_f32 v28, v28
    s_nop 0
    v_mul_f32 v26, v26, v28
    v_cvt_pk_bf16_f32 v27, v75, v75
    v_lshlrev_b32 v27, 16, v27
    v_and_b32 v28, 0xffff0000, v37
    v_add_f32 v27, v27, v28
    v_cvt_pk_bf16_f32 v27, v27, v27
    v_lshlrev_b32 v27, 16, v27
    v_mul_f32 v28, v27, v27
    v_fma_f32 v28, v28, s41, 1.0
    v_mul_f32 v28, v28, v27
    v_mul_f32 v28, s42, v28
    v_exp_f32 v28, v28
    s_nop 0
    v_add_f32 v28, 1.0, v28
    v_rcp_f32 v28, v28
    s_nop 0
    v_mul_f32 v27, v27, v28
    v_cvt_pk_bf16_f32 v16, v24, v25
    v_cvt_pk_bf16_f32 v17, v26, v27
    buffer_store_dwordx2 v[16:17], v9, s[16:19], 0 offen offset:32
    s_nop 0
    v_cvt_pk_bf16_f32 v24, v76, v76
    v_lshlrev_b32 v24, 16, v24
    v_lshlrev_b32 v28, 16, v38
    v_add_f32 v24, v24, v28
    v_cvt_pk_bf16_f32 v24, v24, v24
    v_lshlrev_b32 v24, 16, v24
    v_mul_f32 v28, v24, v24
    v_fma_f32 v28, v28, s41, 1.0
    v_mul_f32 v28, v28, v24
    v_mul_f32 v28, s42, v28
    v_exp_f32 v28, v28
    s_nop 0
    v_add_f32 v28, 1.0, v28
    v_rcp_f32 v28, v28
    s_nop 0
    v_mul_f32 v24, v24, v28
    v_cvt_pk_bf16_f32 v25, v77, v77
    v_lshlrev_b32 v25, 16, v25
    v_and_b32 v28, 0xffff0000, v38
    v_add_f32 v25, v25, v28
    v_cvt_pk_bf16_f32 v25, v25, v25
    v_lshlrev_b32 v25, 16, v25
    v_mul_f32 v28, v25, v25
    v_fma_f32 v28, v28, s41, 1.0
    v_mul_f32 v28, v28, v25
    v_mul_f32 v28, s42, v28
    v_exp_f32 v28, v28
    s_nop 0
    v_add_f32 v28, 1.0, v28
    v_rcp_f32 v28, v28
    s_nop 0
    v_mul_f32 v25, v25, v28
    v_cvt_pk_bf16_f32 v26, v78, v78
    v_lshlrev_b32 v26, 16, v26
    v_lshlrev_b32 v28, 16, v39
    v_add_f32 v26, v26, v28
    v_cvt_pk_bf16_f32 v26, v26, v26
    v_lshlrev_b32 v26, 16, v26
    v_mul_f32 v28, v26, v26
    v_fma_f32 v28, v28, s41, 1.0
    v_mul_f32 v28, v28, v26
    v_mul_f32 v28, s42, v28
    v_exp_f32 v28, v28
    s_nop 0
    v_add_f32 v28, 1.0, v28
    v_rcp_f32 v28, v28
    s_nop 0
    v_mul_f32 v26, v26, v28
    v_cvt_pk_bf16_f32 v27, v79, v79
    v_lshlrev_b32 v27, 16, v27
    v_and_b32 v28, 0xffff0000, v39
    v_add_f32 v27, v27, v28
    v_cvt_pk_bf16_f32 v27, v27, v27
    v_lshlrev_b32 v27, 16, v27
    v_mul_f32 v28, v27, v27
    v_fma_f32 v28, v28, s41, 1.0
    v_mul_f32 v28, v28, v27
    v_mul_f32 v28, s42, v28
    v_exp_f32 v28, v28
    s_nop 0
    v_add_f32 v28, 1.0, v28
    v_rcp_f32 v28, v28
    s_nop 0
    v_mul_f32 v27, v27, v28
    v_cvt_pk_bf16_f32 v16, v24, v25
    v_cvt_pk_bf16_f32 v17, v26, v27
    buffer_store_dwordx2 v[16:17], v9, s[16:19], 0 offen offset:48
    s_nop 0
    v_cvt_pk_bf16_f32 v24, v80, v80
    v_lshlrev_b32 v24, 16, v24
    v_lshlrev_b32 v28, 16, v32
    v_add_f32 v24, v24, v28
    v_cvt_pk_bf16_f32 v24, v24, v24
    v_lshlrev_b32 v24, 16, v24
    v_mul_f32 v28, v24, v24
    v_fma_f32 v28, v28, s41, 1.0
    v_mul_f32 v28, v28, v24
    v_mul_f32 v28, s42, v28
    v_exp_f32 v28, v28
    s_nop 0
    v_add_f32 v28, 1.0, v28
    v_rcp_f32 v28, v28
    s_nop 0
    v_mul_f32 v24, v24, v28
    v_cvt_pk_bf16_f32 v25, v81, v81
    v_lshlrev_b32 v25, 16, v25
    v_and_b32 v28, 0xffff0000, v32
    v_add_f32 v25, v25, v28
    v_cvt_pk_bf16_f32 v25, v25, v25
    v_lshlrev_b32 v25, 16, v25
    v_mul_f32 v28, v25, v25
    v_fma_f32 v28, v28, s41, 1.0
    v_mul_f32 v28, v28, v25
    v_mul_f32 v28, s42, v28
    v_exp_f32 v28, v28
    s_nop 0
    v_add_f32 v28, 1.0, v28
    v_rcp_f32 v28, v28
    s_nop 0
    v_mul_f32 v25, v25, v28
    v_cvt_pk_bf16_f32 v26, v82, v82
    v_lshlrev_b32 v26, 16, v26
    v_lshlrev_b32 v28, 16, v33
    v_add_f32 v26, v26, v28
    v_cvt_pk_bf16_f32 v26, v26, v26
    v_lshlrev_b32 v26, 16, v26
    v_mul_f32 v28, v26, v26
    v_fma_f32 v28, v28, s41, 1.0
    v_mul_f32 v28, v28, v26
    v_mul_f32 v28, s42, v28
    v_exp_f32 v28, v28
    s_nop 0
    v_add_f32 v28, 1.0, v28
    v_rcp_f32 v28, v28
    s_nop 0
    v_mul_f32 v26, v26, v28
    v_cvt_pk_bf16_f32 v27, v83, v83
    v_lshlrev_b32 v27, 16, v27
    v_and_b32 v28, 0xffff0000, v33
    v_add_f32 v27, v27, v28
    v_cvt_pk_bf16_f32 v27, v27, v27
    v_lshlrev_b32 v27, 16, v27
    v_mul_f32 v28, v27, v27
    v_fma_f32 v28, v28, s41, 1.0
    v_mul_f32 v28, v28, v27
    v_mul_f32 v28, s42, v28
    v_exp_f32 v28, v28
    s_nop 0
    v_add_f32 v28, 1.0, v28
    v_rcp_f32 v28, v28
    s_nop 0
    v_mul_f32 v27, v27, v28
    v_cvt_pk_bf16_f32 v16, v24, v25
    v_cvt_pk_bf16_f32 v17, v26, v27
    buffer_store_dwordx2 v[16:17], v8, s[16:19], 0 offen offset:0
    s_nop 0
    v_cvt_pk_bf16_f32 v24, v84, v84
    v_lshlrev_b32 v24, 16, v24
    v_lshlrev_b32 v28, 16, v34
    v_add_f32 v24, v24, v28
    v_cvt_pk_bf16_f32 v24, v24, v24
    v_lshlrev_b32 v24, 16, v24
    v_mul_f32 v28, v24, v24
    v_fma_f32 v28, v28, s41, 1.0
    v_mul_f32 v28, v28, v24
    v_mul_f32 v28, s42, v28
    v_exp_f32 v28, v28
    s_nop 0
    v_add_f32 v28, 1.0, v28
    v_rcp_f32 v28, v28
    s_nop 0
    v_mul_f32 v24, v24, v28
    v_cvt_pk_bf16_f32 v25, v85, v85
    v_lshlrev_b32 v25, 16, v25
    v_and_b32 v28, 0xffff0000, v34
    v_add_f32 v25, v25, v28
    v_cvt_pk_bf16_f32 v25, v25, v25
    v_lshlrev_b32 v25, 16, v25
    v_mul_f32 v28, v25, v25
    v_fma_f32 v28, v28, s41, 1.0
    v_mul_f32 v28, v28, v25
    v_mul_f32 v28, s42, v28
    v_exp_f32 v28, v28
    s_nop 0
    v_add_f32 v28, 1.0, v28
    v_rcp_f32 v28, v28
    s_nop 0
    v_mul_f32 v25, v25, v28
    v_cvt_pk_bf16_f32 v26, v86, v86
    v_lshlrev_b32 v26, 16, v26
    v_lshlrev_b32 v28, 16, v35
    v_add_f32 v26, v26, v28
    v_cvt_pk_bf16_f32 v26, v26, v26
    v_lshlrev_b32 v26, 16, v26
    v_mul_f32 v28, v26, v26
    v_fma_f32 v28, v28, s41, 1.0
    v_mul_f32 v28, v28, v26
    v_mul_f32 v28, s42, v28
    v_exp_f32 v28, v28
    s_nop 0
    v_add_f32 v28, 1.0, v28
    v_rcp_f32 v28, v28
    s_nop 0
    v_mul_f32 v26, v26, v28
    v_cvt_pk_bf16_f32 v27, v87, v87
    v_lshlrev_b32 v27, 16, v27
    v_and_b32 v28, 0xffff0000, v35
    v_add_f32 v27, v27, v28
    v_cvt_pk_bf16_f32 v27, v27, v27
    v_lshlrev_b32 v27, 16, v27
    v_mul_f32 v28, v27, v27
    v_fma_f32 v28, v28, s41, 1.0
    v_mul_f32 v28, v28, v27
    v_mul_f32 v28, s42, v28
    v_exp_f32 v28, v28
    s_nop 0
    v_add_f32 v28, 1.0, v28
    v_rcp_f32 v28, v28
    s_nop 0
    v_mul_f32 v27, v27, v28
    v_cvt_pk_bf16_f32 v16, v24, v25
    v_cvt_pk_bf16_f32 v17, v26, v27
    buffer_store_dwordx2 v[16:17], v8, s[16:19], 0 offen offset:16
    s_nop 0
    v_cvt_pk_bf16_f32 v24, v88, v88
    v_lshlrev_b32 v24, 16, v24
    v_lshlrev_b32 v28, 16, v36
    v_add_f32 v24, v24, v28
    v_cvt_pk_bf16_f32 v24, v24, v24
    v_lshlrev_b32 v24, 16, v24
    v_mul_f32 v28, v24, v24
    v_fma_f32 v28, v28, s41, 1.0
    v_mul_f32 v28, v28, v24
    v_mul_f32 v28, s42, v28
    v_exp_f32 v28, v28
    s_nop 0
    v_add_f32 v28, 1.0, v28
    v_rcp_f32 v28, v28
    s_nop 0
    v_mul_f32 v24, v24, v28
    v_cvt_pk_bf16_f32 v25, v89, v89
    v_lshlrev_b32 v25, 16, v25
    v_and_b32 v28, 0xffff0000, v36
    v_add_f32 v25, v25, v28
    v_cvt_pk_bf16_f32 v25, v25, v25
    v_lshlrev_b32 v25, 16, v25
    v_mul_f32 v28, v25, v25
    v_fma_f32 v28, v28, s41, 1.0
    v_mul_f32 v28, v28, v25
    v_mul_f32 v28, s42, v28
    v_exp_f32 v28, v28
    s_nop 0
    v_add_f32 v28, 1.0, v28
    v_rcp_f32 v28, v28
    s_nop 0
    v_mul_f32 v25, v25, v28
    v_cvt_pk_bf16_f32 v26, v90, v90
    v_lshlrev_b32 v26, 16, v26
    v_lshlrev_b32 v28, 16, v37
    v_add_f32 v26, v26, v28
    v_cvt_pk_bf16_f32 v26, v26, v26
    v_lshlrev_b32 v26, 16, v26
    v_mul_f32 v28, v26, v26
    v_fma_f32 v28, v28, s41, 1.0
    v_mul_f32 v28, v28, v26
    v_mul_f32 v28, s42, v28
    v_exp_f32 v28, v28
    s_nop 0
    v_add_f32 v28, 1.0, v28
    v_rcp_f32 v28, v28
    s_nop 0
    v_mul_f32 v26, v26, v28
    v_cvt_pk_bf16_f32 v27, v91, v91
    v_lshlrev_b32 v27, 16, v27
    v_and_b32 v28, 0xffff0000, v37
    v_add_f32 v27, v27, v28
    v_cvt_pk_bf16_f32 v27, v27, v27
    v_lshlrev_b32 v27, 16, v27
    v_mul_f32 v28, v27, v27
    v_fma_f32 v28, v28, s41, 1.0
    v_mul_f32 v28, v28, v27
    v_mul_f32 v28, s42, v28
    v_exp_f32 v28, v28
    s_nop 0
    v_add_f32 v28, 1.0, v28
    v_rcp_f32 v28, v28
    s_nop 0
    v_mul_f32 v27, v27, v28
    v_cvt_pk_bf16_f32 v16, v24, v25
    v_cvt_pk_bf16_f32 v17, v26, v27
    buffer_store_dwordx2 v[16:17], v8, s[16:19], 0 offen offset:32
    s_nop 0
    v_cvt_pk_bf16_f32 v24, v92, v92
    v_lshlrev_b32 v24, 16, v24
    v_lshlrev_b32 v28, 16, v38
    v_add_f32 v24, v24, v28
    v_cvt_pk_bf16_f32 v24, v24, v24
    v_lshlrev_b32 v24, 16, v24
    v_mul_f32 v28, v24, v24
    v_fma_f32 v28, v28, s41, 1.0
    v_mul_f32 v28, v28, v24
    v_mul_f32 v28, s42, v28
    v_exp_f32 v28, v28
    s_nop 0
    v_add_f32 v28, 1.0, v28
    v_rcp_f32 v28, v28
    s_nop 0
    v_mul_f32 v24, v24, v28
    v_cvt_pk_bf16_f32 v25, v93, v93
    v_lshlrev_b32 v25, 16, v25
    v_and_b32 v28, 0xffff0000, v38
    v_add_f32 v25, v25, v28
    v_cvt_pk_bf16_f32 v25, v25, v25
    v_lshlrev_b32 v25, 16, v25
    v_mul_f32 v28, v25, v25
    v_fma_f32 v28, v28, s41, 1.0
    v_mul_f32 v28, v28, v25
    v_mul_f32 v28, s42, v28
    v_exp_f32 v28, v28
    s_nop 0
    v_add_f32 v28, 1.0, v28
    v_rcp_f32 v28, v28
    s_nop 0
    v_mul_f32 v25, v25, v28
    v_cvt_pk_bf16_f32 v26, v94, v94
    v_lshlrev_b32 v26, 16, v26
    v_lshlrev_b32 v28, 16, v39
    v_add_f32 v26, v26, v28
    v_cvt_pk_bf16_f32 v26, v26, v26
    v_lshlrev_b32 v26, 16, v26
    v_mul_f32 v28, v26, v26
    v_fma_f32 v28, v28, s41, 1.0
    v_mul_f32 v28, v28, v26
    v_mul_f32 v28, s42, v28
    v_exp_f32 v28, v28
    s_nop 0
    v_add_f32 v28, 1.0, v28
    v_rcp_f32 v28, v28
    s_nop 0
    v_mul_f32 v26, v26, v28
    v_cvt_pk_bf16_f32 v27, v95, v95
    v_lshlrev_b32 v27, 16, v27
    v_and_b32 v28, 0xffff0000, v39
    v_add_f32 v27, v27, v28
    v_cvt_pk_bf16_f32 v27, v27, v27
    v_lshlrev_b32 v27, 16, v27
    v_mul_f32 v28, v27, v27
    v_fma_f32 v28, v28, s41, 1.0
    v_mul_f32 v28, v28, v27
    v_mul_f32 v28, s42, v28
    v_exp_f32 v28, v28
    s_nop 0
    v_add_f32 v28, 1.0, v28
    v_rcp_f32 v28, v28
    s_nop 0
    v_mul_f32 v27, v27, v28
    v_cvt_pk_bf16_f32 v16, v24, v25
    v_cvt_pk_bf16_f32 v17, v26, v27
    buffer_store_dwordx2 v[16:17], v8, s[16:19], 0 offen offset:48
    s_nop 0
    buffer_load_dwordx2 v[32:33], v10, s[20:23], 0 offen offset:64
    buffer_load_dwordx2 v[34:35], v10, s[20:23], 0 offen offset:80
    buffer_load_dwordx2 v[36:37], v10, s[20:23], 0 offen offset:96
    buffer_load_dwordx2 v[38:39], v10, s[20:23], 0 offen offset:112
    s_waitcnt vmcnt(0)
    v_cvt_pk_bf16_f32 v24, v96, v96
    v_lshlrev_b32 v24, 16, v24
    v_lshlrev_b32 v28, 16, v32
    v_add_f32 v24, v24, v28
    v_cvt_pk_bf16_f32 v24, v24, v24
    v_lshlrev_b32 v24, 16, v24
    v_mul_f32 v28, v24, v24
    v_fma_f32 v28, v28, s41, 1.0
    v_mul_f32 v28, v28, v24
    v_mul_f32 v28, s42, v28
    v_exp_f32 v28, v28
    s_nop 0
    v_add_f32 v28, 1.0, v28
    v_rcp_f32 v28, v28
    s_nop 0
    v_mul_f32 v24, v24, v28
    v_cvt_pk_bf16_f32 v25, v97, v97
    v_lshlrev_b32 v25, 16, v25
    v_and_b32 v28, 0xffff0000, v32
    v_add_f32 v25, v25, v28
    v_cvt_pk_bf16_f32 v25, v25, v25
    v_lshlrev_b32 v25, 16, v25
    v_mul_f32 v28, v25, v25
    v_fma_f32 v28, v28, s41, 1.0
    v_mul_f32 v28, v28, v25
    v_mul_f32 v28, s42, v28
    v_exp_f32 v28, v28
    s_nop 0
    v_add_f32 v28, 1.0, v28
    v_rcp_f32 v28, v28
    s_nop 0
    v_mul_f32 v25, v25, v28
    v_cvt_pk_bf16_f32 v26, v98, v98
    v_lshlrev_b32 v26, 16, v26
    v_lshlrev_b32 v28, 16, v33
    v_add_f32 v26, v26, v28
    v_cvt_pk_bf16_f32 v26, v26, v26
    v_lshlrev_b32 v26, 16, v26
    v_mul_f32 v28, v26, v26
    v_fma_f32 v28, v28, s41, 1.0
    v_mul_f32 v28, v28, v26
    v_mul_f32 v28, s42, v28
    v_exp_f32 v28, v28
    s_nop 0
    v_add_f32 v28, 1.0, v28
    v_rcp_f32 v28, v28
    s_nop 0
    v_mul_f32 v26, v26, v28
    v_cvt_pk_bf16_f32 v27, v99, v99
    v_lshlrev_b32 v27, 16, v27
    v_and_b32 v28, 0xffff0000, v33
    v_add_f32 v27, v27, v28
    v_cvt_pk_bf16_f32 v27, v27, v27
    v_lshlrev_b32 v27, 16, v27
    v_mul_f32 v28, v27, v27
    v_fma_f32 v28, v28, s41, 1.0
    v_mul_f32 v28, v28, v27
    v_mul_f32 v28, s42, v28
    v_exp_f32 v28, v28
    s_nop 0
    v_add_f32 v28, 1.0, v28
    v_rcp_f32 v28, v28
    s_nop 0
    v_mul_f32 v27, v27, v28
    v_cvt_pk_bf16_f32 v16, v24, v25
    v_cvt_pk_bf16_f32 v17, v26, v27
    buffer_store_dwordx2 v[16:17], v9, s[16:19], 0 offen offset:64
    s_nop 0
    v_cvt_pk_bf16_f32 v24, v100, v100
    v_lshlrev_b32 v24, 16, v24
    v_lshlrev_b32 v28, 16, v34
    v_add_f32 v24, v24, v28
    v_cvt_pk_bf16_f32 v24, v24, v24
    v_lshlrev_b32 v24, 16, v24
    v_mul_f32 v28, v24, v24
    v_fma_f32 v28, v28, s41, 1.0
    v_mul_f32 v28, v28, v24
    v_mul_f32 v28, s42, v28
    v_exp_f32 v28, v28
    s_nop 0
    v_add_f32 v28, 1.0, v28
    v_rcp_f32 v28, v28
    s_nop 0
    v_mul_f32 v24, v24, v28
    v_cvt_pk_bf16_f32 v25, v101, v101
    v_lshlrev_b32 v25, 16, v25
    v_and_b32 v28, 0xffff0000, v34
    v_add_f32 v25, v25, v28
    v_cvt_pk_bf16_f32 v25, v25, v25
    v_lshlrev_b32 v25, 16, v25
    v_mul_f32 v28, v25, v25
    v_fma_f32 v28, v28, s41, 1.0
    v_mul_f32 v28, v28, v25
    v_mul_f32 v28, s42, v28
    v_exp_f32 v28, v28
    s_nop 0
    v_add_f32 v28, 1.0, v28
    v_rcp_f32 v28, v28
    s_nop 0
    v_mul_f32 v25, v25, v28
    v_cvt_pk_bf16_f32 v26, v102, v102
    v_lshlrev_b32 v26, 16, v26
    v_lshlrev_b32 v28, 16, v35
    v_add_f32 v26, v26, v28
    v_cvt_pk_bf16_f32 v26, v26, v26
    v_lshlrev_b32 v26, 16, v26
    v_mul_f32 v28, v26, v26
    v_fma_f32 v28, v28, s41, 1.0
    v_mul_f32 v28, v28, v26
    v_mul_f32 v28, s42, v28
    v_exp_f32 v28, v28
    s_nop 0
    v_add_f32 v28, 1.0, v28
    v_rcp_f32 v28, v28
    s_nop 0
    v_mul_f32 v26, v26, v28
    v_cvt_pk_bf16_f32 v27, v103, v103
    v_lshlrev_b32 v27, 16, v27
    v_and_b32 v28, 0xffff0000, v35
    v_add_f32 v27, v27, v28
    v_cvt_pk_bf16_f32 v27, v27, v27
    v_lshlrev_b32 v27, 16, v27
    v_mul_f32 v28, v27, v27
    v_fma_f32 v28, v28, s41, 1.0
    v_mul_f32 v28, v28, v27
    v_mul_f32 v28, s42, v28
    v_exp_f32 v28, v28
    s_nop 0
    v_add_f32 v28, 1.0, v28
    v_rcp_f32 v28, v28
    s_nop 0
    v_mul_f32 v27, v27, v28
    v_cvt_pk_bf16_f32 v16, v24, v25
    v_cvt_pk_bf16_f32 v17, v26, v27
    buffer_store_dwordx2 v[16:17], v9, s[16:19], 0 offen offset:80
    s_nop 0
    v_cvt_pk_bf16_f32 v24, v104, v104
    v_lshlrev_b32 v24, 16, v24
    v_lshlrev_b32 v28, 16, v36
    v_add_f32 v24, v24, v28
    v_cvt_pk_bf16_f32 v24, v24, v24
    v_lshlrev_b32 v24, 16, v24
    v_mul_f32 v28, v24, v24
    v_fma_f32 v28, v28, s41, 1.0
    v_mul_f32 v28, v28, v24
    v_mul_f32 v28, s42, v28
    v_exp_f32 v28, v28
    s_nop 0
    v_add_f32 v28, 1.0, v28
    v_rcp_f32 v28, v28
    s_nop 0
    v_mul_f32 v24, v24, v28
    v_cvt_pk_bf16_f32 v25, v105, v105
    v_lshlrev_b32 v25, 16, v25
    v_and_b32 v28, 0xffff0000, v36
    v_add_f32 v25, v25, v28
    v_cvt_pk_bf16_f32 v25, v25, v25
    v_lshlrev_b32 v25, 16, v25
    v_mul_f32 v28, v25, v25
    v_fma_f32 v28, v28, s41, 1.0
    v_mul_f32 v28, v28, v25
    v_mul_f32 v28, s42, v28
    v_exp_f32 v28, v28
    s_nop 0
    v_add_f32 v28, 1.0, v28
    v_rcp_f32 v28, v28
    s_nop 0
    v_mul_f32 v25, v25, v28
    v_cvt_pk_bf16_f32 v26, v106, v106
    v_lshlrev_b32 v26, 16, v26
    v_lshlrev_b32 v28, 16, v37
    v_add_f32 v26, v26, v28
    v_cvt_pk_bf16_f32 v26, v26, v26
    v_lshlrev_b32 v26, 16, v26
    v_mul_f32 v28, v26, v26
    v_fma_f32 v28, v28, s41, 1.0
    v_mul_f32 v28, v28, v26
    v_mul_f32 v28, s42, v28
    v_exp_f32 v28, v28
    s_nop 0
    v_add_f32 v28, 1.0, v28
    v_rcp_f32 v28, v28
    s_nop 0
    v_mul_f32 v26, v26, v28
    v_cvt_pk_bf16_f32 v27, v107, v107
    v_lshlrev_b32 v27, 16, v27
    v_and_b32 v28, 0xffff0000, v37
    v_add_f32 v27, v27, v28
    v_cvt_pk_bf16_f32 v27, v27, v27
    v_lshlrev_b32 v27, 16, v27
    v_mul_f32 v28, v27, v27
    v_fma_f32 v28, v28, s41, 1.0
    v_mul_f32 v28, v28, v27
    v_mul_f32 v28, s42, v28
    v_exp_f32 v28, v28
    s_nop 0
    v_add_f32 v28, 1.0, v28
    v_rcp_f32 v28, v28
    s_nop 0
    v_mul_f32 v27, v27, v28
    v_cvt_pk_bf16_f32 v16, v24, v25
    v_cvt_pk_bf16_f32 v17, v26, v27
    buffer_store_dwordx2 v[16:17], v9, s[16:19], 0 offen offset:96
    s_nop 0
    v_cvt_pk_bf16_f32 v24, v108, v108
    v_lshlrev_b32 v24, 16, v24
    v_lshlrev_b32 v28, 16, v38
    v_add_f32 v24, v24, v28
    v_cvt_pk_bf16_f32 v24, v24, v24
    v_lshlrev_b32 v24, 16, v24
    v_mul_f32 v28, v24, v24
    v_fma_f32 v28, v28, s41, 1.0
    v_mul_f32 v28, v28, v24
    v_mul_f32 v28, s42, v28
    v_exp_f32 v28, v28
    s_nop 0
    v_add_f32 v28, 1.0, v28
    v_rcp_f32 v28, v28
    s_nop 0
    v_mul_f32 v24, v24, v28
    v_cvt_pk_bf16_f32 v25, v109, v109
    v_lshlrev_b32 v25, 16, v25
    v_and_b32 v28, 0xffff0000, v38
    v_add_f32 v25, v25, v28
    v_cvt_pk_bf16_f32 v25, v25, v25
    v_lshlrev_b32 v25, 16, v25
    v_mul_f32 v28, v25, v25
    v_fma_f32 v28, v28, s41, 1.0
    v_mul_f32 v28, v28, v25
    v_mul_f32 v28, s42, v28
    v_exp_f32 v28, v28
    s_nop 0
    v_add_f32 v28, 1.0, v28
    v_rcp_f32 v28, v28
    s_nop 0
    v_mul_f32 v25, v25, v28
    v_cvt_pk_bf16_f32 v26, v110, v110
    v_lshlrev_b32 v26, 16, v26
    v_lshlrev_b32 v28, 16, v39
    v_add_f32 v26, v26, v28
    v_cvt_pk_bf16_f32 v26, v26, v26
    v_lshlrev_b32 v26, 16, v26
    v_mul_f32 v28, v26, v26
    v_fma_f32 v28, v28, s41, 1.0
    v_mul_f32 v28, v28, v26
    v_mul_f32 v28, s42, v28
    v_exp_f32 v28, v28
    s_nop 0
    v_add_f32 v28, 1.0, v28
    v_rcp_f32 v28, v28
    s_nop 0
    v_mul_f32 v26, v26, v28
    v_cvt_pk_bf16_f32 v27, v111, v111
    v_lshlrev_b32 v27, 16, v27
    v_and_b32 v28, 0xffff0000, v39
    v_add_f32 v27, v27, v28
    v_cvt_pk_bf16_f32 v27, v27, v27
    v_lshlrev_b32 v27, 16, v27
    v_mul_f32 v28, v27, v27
    v_fma_f32 v28, v28, s41, 1.0
    v_mul_f32 v28, v28, v27
    v_mul_f32 v28, s42, v28
    v_exp_f32 v28, v28
    s_nop 0
    v_add_f32 v28, 1.0, v28
    v_rcp_f32 v28, v28
    s_nop 0
    v_mul_f32 v27, v27, v28
    v_cvt_pk_bf16_f32 v16, v24, v25
    v_cvt_pk_bf16_f32 v17, v26, v27
    buffer_store_dwordx2 v[16:17], v9, s[16:19], 0 offen offset:112
    s_nop 0
    v_cvt_pk_bf16_f32 v24, v112, v112
    v_lshlrev_b32 v24, 16, v24
    v_lshlrev_b32 v28, 16, v32
    v_add_f32 v24, v24, v28
    v_cvt_pk_bf16_f32 v24, v24, v24
    v_lshlrev_b32 v24, 16, v24
    v_mul_f32 v28, v24, v24
    v_fma_f32 v28, v28, s41, 1.0
    v_mul_f32 v28, v28, v24
    v_mul_f32 v28, s42, v28
    v_exp_f32 v28, v28
    s_nop 0
    v_add_f32 v28, 1.0, v28
    v_rcp_f32 v28, v28
    s_nop 0
    v_mul_f32 v24, v24, v28
    v_cvt_pk_bf16_f32 v25, v113, v113
    v_lshlrev_b32 v25, 16, v25
    v_and_b32 v28, 0xffff0000, v32
    v_add_f32 v25, v25, v28
    v_cvt_pk_bf16_f32 v25, v25, v25
    v_lshlrev_b32 v25, 16, v25
    v_mul_f32 v28, v25, v25
    v_fma_f32 v28, v28, s41, 1.0
    v_mul_f32 v28, v28, v25
    v_mul_f32 v28, s42, v28
    v_exp_f32 v28, v28
    s_nop 0
    v_add_f32 v28, 1.0, v28
    v_rcp_f32 v28, v28
    s_nop 0
    v_mul_f32 v25, v25, v28
    v_cvt_pk_bf16_f32 v26, v114, v114
    v_lshlrev_b32 v26, 16, v26
    v_lshlrev_b32 v28, 16, v33
    v_add_f32 v26, v26, v28
    v_cvt_pk_bf16_f32 v26, v26, v26
    v_lshlrev_b32 v26, 16, v26
    v_mul_f32 v28, v26, v26
    v_fma_f32 v28, v28, s41, 1.0
    v_mul_f32 v28, v28, v26
    v_mul_f32 v28, s42, v28
    v_exp_f32 v28, v28
    s_nop 0
    v_add_f32 v28, 1.0, v28
    v_rcp_f32 v28, v28
    s_nop 0
    v_mul_f32 v26, v26, v28
    v_cvt_pk_bf16_f32 v27, v115, v115
    v_lshlrev_b32 v27, 16, v27
    v_and_b32 v28, 0xffff0000, v33
    v_add_f32 v27, v27, v28
    v_cvt_pk_bf16_f32 v27, v27, v27
    v_lshlrev_b32 v27, 16, v27
    v_mul_f32 v28, v27, v27
    v_fma_f32 v28, v28, s41, 1.0
    v_mul_f32 v28, v28, v27
    v_mul_f32 v28, s42, v28
    v_exp_f32 v28, v28
    s_nop 0
    v_add_f32 v28, 1.0, v28
    v_rcp_f32 v28, v28
    s_nop 0
    v_mul_f32 v27, v27, v28
    v_cvt_pk_bf16_f32 v16, v24, v25
    v_cvt_pk_bf16_f32 v17, v26, v27
    buffer_store_dwordx2 v[16:17], v8, s[16:19], 0 offen offset:64
    s_nop 0
    v_cvt_pk_bf16_f32 v24, v116, v116
    v_lshlrev_b32 v24, 16, v24
    v_lshlrev_b32 v28, 16, v34
    v_add_f32 v24, v24, v28
    v_cvt_pk_bf16_f32 v24, v24, v24
    v_lshlrev_b32 v24, 16, v24
    v_mul_f32 v28, v24, v24
    v_fma_f32 v28, v28, s41, 1.0
    v_mul_f32 v28, v28, v24
    v_mul_f32 v28, s42, v28
    v_exp_f32 v28, v28
    s_nop 0
    v_add_f32 v28, 1.0, v28
    v_rcp_f32 v28, v28
    s_nop 0
    v_mul_f32 v24, v24, v28
    v_cvt_pk_bf16_f32 v25, v117, v117
    v_lshlrev_b32 v25, 16, v25
    v_and_b32 v28, 0xffff0000, v34
    v_add_f32 v25, v25, v28
    v_cvt_pk_bf16_f32 v25, v25, v25
    v_lshlrev_b32 v25, 16, v25
    v_mul_f32 v28, v25, v25
    v_fma_f32 v28, v28, s41, 1.0
    v_mul_f32 v28, v28, v25
    v_mul_f32 v28, s42, v28
    v_exp_f32 v28, v28
    s_nop 0
    v_add_f32 v28, 1.0, v28
    v_rcp_f32 v28, v28
    s_nop 0
    v_mul_f32 v25, v25, v28
    v_cvt_pk_bf16_f32 v26, v118, v118
    v_lshlrev_b32 v26, 16, v26
    v_lshlrev_b32 v28, 16, v35
    v_add_f32 v26, v26, v28
    v_cvt_pk_bf16_f32 v26, v26, v26
    v_lshlrev_b32 v26, 16, v26
    v_mul_f32 v28, v26, v26
    v_fma_f32 v28, v28, s41, 1.0
    v_mul_f32 v28, v28, v26
    v_mul_f32 v28, s42, v28
    v_exp_f32 v28, v28
    s_nop 0
    v_add_f32 v28, 1.0, v28
    v_rcp_f32 v28, v28
    s_nop 0
    v_mul_f32 v26, v26, v28
    v_cvt_pk_bf16_f32 v27, v119, v119
    v_lshlrev_b32 v27, 16, v27
    v_and_b32 v28, 0xffff0000, v35
    v_add_f32 v27, v27, v28
    v_cvt_pk_bf16_f32 v27, v27, v27
    v_lshlrev_b32 v27, 16, v27
    v_mul_f32 v28, v27, v27
    v_fma_f32 v28, v28, s41, 1.0
    v_mul_f32 v28, v28, v27
    v_mul_f32 v28, s42, v28
    v_exp_f32 v28, v28
    s_nop 0
    v_add_f32 v28, 1.0, v28
    v_rcp_f32 v28, v28
    s_nop 0
    v_mul_f32 v27, v27, v28
    v_cvt_pk_bf16_f32 v16, v24, v25
    v_cvt_pk_bf16_f32 v17, v26, v27
    buffer_store_dwordx2 v[16:17], v8, s[16:19], 0 offen offset:80
    s_nop 0
    v_cvt_pk_bf16_f32 v24, v120, v120
    v_lshlrev_b32 v24, 16, v24
    v_lshlrev_b32 v28, 16, v36
    v_add_f32 v24, v24, v28
    v_cvt_pk_bf16_f32 v24, v24, v24
    v_lshlrev_b32 v24, 16, v24
    v_mul_f32 v28, v24, v24
    v_fma_f32 v28, v28, s41, 1.0
    v_mul_f32 v28, v28, v24
    v_mul_f32 v28, s42, v28
    v_exp_f32 v28, v28
    s_nop 0
    v_add_f32 v28, 1.0, v28
    v_rcp_f32 v28, v28
    s_nop 0
    v_mul_f32 v24, v24, v28
    v_cvt_pk_bf16_f32 v25, v121, v121
    v_lshlrev_b32 v25, 16, v25
    v_and_b32 v28, 0xffff0000, v36
    v_add_f32 v25, v25, v28
    v_cvt_pk_bf16_f32 v25, v25, v25
    v_lshlrev_b32 v25, 16, v25
    v_mul_f32 v28, v25, v25
    v_fma_f32 v28, v28, s41, 1.0
    v_mul_f32 v28, v28, v25
    v_mul_f32 v28, s42, v28
    v_exp_f32 v28, v28
    s_nop 0
    v_add_f32 v28, 1.0, v28
    v_rcp_f32 v28, v28
    s_nop 0
    v_mul_f32 v25, v25, v28
    v_cvt_pk_bf16_f32 v26, v122, v122
    v_lshlrev_b32 v26, 16, v26
    v_lshlrev_b32 v28, 16, v37
    v_add_f32 v26, v26, v28
    v_cvt_pk_bf16_f32 v26, v26, v26
    v_lshlrev_b32 v26, 16, v26
    v_mul_f32 v28, v26, v26
    v_fma_f32 v28, v28, s41, 1.0
    v_mul_f32 v28, v28, v26
    v_mul_f32 v28, s42, v28
    v_exp_f32 v28, v28
    s_nop 0
    v_add_f32 v28, 1.0, v28
    v_rcp_f32 v28, v28
    s_nop 0
    v_mul_f32 v26, v26, v28
    v_cvt_pk_bf16_f32 v27, v123, v123
    v_lshlrev_b32 v27, 16, v27
    v_and_b32 v28, 0xffff0000, v37
    v_add_f32 v27, v27, v28
    v_cvt_pk_bf16_f32 v27, v27, v27
    v_lshlrev_b32 v27, 16, v27
    v_mul_f32 v28, v27, v27
    v_fma_f32 v28, v28, s41, 1.0
    v_mul_f32 v28, v28, v27
    v_mul_f32 v28, s42, v28
    v_exp_f32 v28, v28
    s_nop 0
    v_add_f32 v28, 1.0, v28
    v_rcp_f32 v28, v28
    s_nop 0
    v_mul_f32 v27, v27, v28
    v_cvt_pk_bf16_f32 v16, v24, v25
    v_cvt_pk_bf16_f32 v17, v26, v27
    buffer_store_dwordx2 v[16:17], v8, s[16:19], 0 offen offset:96
    s_nop 0
    v_cvt_pk_bf16_f32 v24, v124, v124
    v_lshlrev_b32 v24, 16, v24
    v_lshlrev_b32 v28, 16, v38
    v_add_f32 v24, v24, v28
    v_cvt_pk_bf16_f32 v24, v24, v24
    v_lshlrev_b32 v24, 16, v24
    v_mul_f32 v28, v24, v24
    v_fma_f32 v28, v28, s41, 1.0
    v_mul_f32 v28, v28, v24
    v_mul_f32 v28, s42, v28
    v_exp_f32 v28, v28
    s_nop 0
    v_add_f32 v28, 1.0, v28
    v_rcp_f32 v28, v28
    s_nop 0
    v_mul_f32 v24, v24, v28
    v_cvt_pk_bf16_f32 v25, v125, v125
    v_lshlrev_b32 v25, 16, v25
    v_and_b32 v28, 0xffff0000, v38
    v_add_f32 v25, v25, v28
    v_cvt_pk_bf16_f32 v25, v25, v25
    v_lshlrev_b32 v25, 16, v25
    v_mul_f32 v28, v25, v25
    v_fma_f32 v28, v28, s41, 1.0
    v_mul_f32 v28, v28, v25
    v_mul_f32 v28, s42, v28
    v_exp_f32 v28, v28
    s_nop 0
    v_add_f32 v28, 1.0, v28
    v_rcp_f32 v28, v28
    s_nop 0
    v_mul_f32 v25, v25, v28
    v_cvt_pk_bf16_f32 v26, v126, v126
    v_lshlrev_b32 v26, 16, v26
    v_lshlrev_b32 v28, 16, v39
    v_add_f32 v26, v26, v28
    v_cvt_pk_bf16_f32 v26, v26, v26
    v_lshlrev_b32 v26, 16, v26
    v_mul_f32 v28, v26, v26
    v_fma_f32 v28, v28, s41, 1.0
    v_mul_f32 v28, v28, v26
    v_mul_f32 v28, s42, v28
    v_exp_f32 v28, v28
    s_nop 0
    v_add_f32 v28, 1.0, v28
    v_rcp_f32 v28, v28
    s_nop 0
    v_mul_f32 v26, v26, v28
    v_cvt_pk_bf16_f32 v27, v127, v127
    v_lshlrev_b32 v27, 16, v27
    v_and_b32 v28, 0xffff0000, v39
    v_add_f32 v27, v27, v28
    v_cvt_pk_bf16_f32 v27, v27, v27
    v_lshlrev_b32 v27, 16, v27
    v_mul_f32 v28, v27, v27
    v_fma_f32 v28, v28, s41, 1.0
    v_mul_f32 v28, v28, v27
    v_mul_f32 v28, s42, v28
    v_exp_f32 v28, v28
    s_nop 0
    v_add_f32 v28, 1.0, v28
    v_rcp_f32 v28, v28
    s_nop 0
    v_mul_f32 v27, v27, v28
    v_cvt_pk_bf16_f32 v16, v24, v25
    v_cvt_pk_bf16_f32 v17, v26, v27
    buffer_store_dwordx2 v[16:17], v8, s[16:19], 0 offen offset:112
    s_nop 0
L_g1_end:
    s_endpgm
.globl attn_kernel
.p2align 8
.type attn_kernel,@function
attn_kernel:
    s_cmp_ge_u32 s2, 256
    s_cbranch_scc1 L_at_end
    s_load_dwordx2 s[4:5], s[0:1], 8
    s_load_dwordx2 s[6:7], s[0:1], 16
    s_load_dwordx2 s[36:37], s[0:1], 96
    s_waitcnt lgkmcnt(0)
    s_mov_b32 s8, s4
    s_mov_b32 s9, s5
    s_mov_b32 s10, 25165824
    s_mov_b32 s11, 0x20000
    s_mov_b32 s12, s6
    s_mov_b32 s13, s7
    s_mov_b32 s14, 25165824
    s_mov_b32 s15, 0x20000
    s_add_u32 s16, s36, 8388608
    s_addc_u32 s17, s37, 0
    s_mov_b32 s18, 25690112
    s_mov_b32 s19, 0x20000
    s_add_u32 s20, s36, 50331648
    s_addc_u32 s21, s37, 0
    s_mov_b32 s22, 25690112
    s_mov_b32 s23, 0x20000
    s_and_b32 s33, s2, 31
    s_lshr_b32 s34, s2, 5
    s_mul_i32 s26, s33, 786432
    s_mov_b32 s25, s26
    v_and_b32 v224, 63, v0
    v_lshrrev_b32 v225, 6, v0
    s_nop 1
    v_readfirstlane_b32 s30, v225
    v_and_b32 v226, 31, v224
    v_lshrrev_b32 v227, 5, v224
    s_lshl_b32 s35, s34, 8
    v_lshl_add_u32 v228, v225, 5, v226
    v_add_u32 v228, s35, v228
    s_movk_i32 s31, 12544
    v_mul_lo_u32 v229, v228, s31
    s_mul_i32 s35, s33, 384
    v_lshl_add_u32 v229, v227, 4, v229
    v_add_u32 v229, s35, v229
    buffer_load_dwordx4 v[160:163], v229, s[16:19], 0 offen offset:0
    buffer_load_dwordx4 v[164:167], v229, s[16:19], 0 offen offset:32
    buffer_load_dwordx4 v[168:171], v229, s[16:19], 0 offen offset:64
    buffer_load_dwordx4 v[172:175], v229, s[16:19], 0 offen offset:96
    buffer_load_dwordx4 v[176:179], v229, s[16:19], 0 offen offset:128
    buffer_load_dwordx4 v[180:183], v229, s[16:19], 0 offen offset:160
    buffer_load_dwordx4 v[184:187], v229, s[16:19], 0 offen offset:192
    buffer_load_dwordx4 v[188:191], v229, s[16:19], 0 offen offset:224
    buffer_load_dwordx4 v[192:195], v229, s[16:19], 0 offen offset:256
    buffer_load_dwordx4 v[196:199], v229, s[16:19], 0 offen offset:288
    buffer_load_dwordx4 v[200:203], v229, s[16:19], 0 offen offset:320
    buffer_load_dwordx4 v[204:207], v229, s[16:19], 0 offen offset:352
    v_lshl_add_u32 v230, v225, 6, v224
    v_add_u32 v230, 0, v230
    s_movk_i32 s31, 2731
    v_mul_lo_u32 v231, v230, s31
    v_lshrrev_b32 v231, 16, v231
    v_mul_u32_u24 v232, 24, v231
    v_sub_u32 v232, v230, v232
    v_lshrrev_b32 v233, 1, v231
    v_and_b32 v234, 7, v233
    v_xor_b32 v234, v234, v232
    v_mul_u32_u24 v235, 384, v231
    v_lshl_add_u32 v240, v234, 4, v235
    v_and_b32 v234, 1, v233
    v_lshlrev_b32 v234, 2, v234
    v_xor_b32 v234, v234, v232
    v_lshl_add_u32 v243, v234, 4, v235
    v_lshl_add_u32 v230, v225, 6, v224
    v_add_u32 v230, 512, v230
    s_movk_i32 s31, 2731
    v_mul_lo_u32 v231, v230, s31
    v_lshrrev_b32 v231, 16, v231
    v_mul_u32_u24 v232, 24, v231
    v_sub_u32 v232, v230, v232
    v_lshrrev_b32 v233, 1, v231
    v_and_b32 v234, 7, v233
    v_xor_b32 v234, v234, v232
    v_mul_u32_u24 v235, 384, v231
    v_lshl_add_u32 v241, v234, 4, v235
    v_and_b32 v234, 1, v233
    v_lshlrev_b32 v234, 2, v234
    v_xor_b32 v234, v234, v232
    v_lshl_add_u32 v244, v234, 4, v235
    v_lshl_add_u32 v230, v225, 6, v224
    v_add_u32 v230, 1024, v230
    s_movk_i32 s31, 2731
    v_mul_lo_u32 v231, v230, s31
    v_lshrrev_b32 v231, 16, v231
    v_mul_u32_u24 v232, 24, v231
    v_sub_u32 v232, v230, v232
    v_lshrrev_b32 v233, 1, v231
    v_and_b32 v234, 7, v233
    v_xor_b32 v234, v234, v232
    v_mul_u32_u24 v235, 384, v231
    v_lshl_add_u32 v242, v234, 4, v235
    v_and_b32 v234, 1, v233
    v_lshlrev_b32 v234, 2, v234
    v_xor_b32 v234, v234, v232
    v_lshl_add_u32 v245, v234, 4, v235
    v_lshrrev_b32 v230, 1, v226
    v_and_b32 v230, 7, v230
    v_mul_u32_u24 v231, 384, v226
    v_add_u32 v232, 0, v227
    v_xor_b32 v232, v232, v230
    v_lshl_add_u32 v246, v232, 4, v231
    v_add_u32 v232, 2, v227
    v_xor_b32 v232, v232, v230
    v_lshl_add_u32 v247, v232, 4, v231
    v_add_u32 v232, 4, v227
    v_xor_b32 v232, v232, v230
    v_lshl_add_u32 v248, v232, 4, v231
    v_add_u32 v232, 6, v227
    v_xor_b32 v232, v232, v230
    v_lshl_add_u32 v249, v232, 4, v231
    v_and_b32 v230, 15, v224
    v_lshrrev_b32 v230, 2, v230
    v_lshl_add_u32 v230, v227, 2, v230
    v_mul_u32_u24 v230, 384, v230
    v_lshrrev_b32 v231, 4, v224
    v_and_b32 v231, 1, v231
    v_lshl_add_u32 v230, v231, 5, v230
    v_and_b32 v231, 3, v224
    v_lshl_add_u32 v230, v231, 3, v230
    v_add_u32 v230, 49152, v230
    v_lshrrev_b32 v231, 3, v224
    v_and_b32 v231, 1, v231
    v_lshl_add_u32 v250, v231, 6, v230
    v_xor_b32 v231, 1, v231
    v_lshl_add_u32 v251, v231, 6, v230
    v_mov_b32 v0, 0
    v_mov_b32 v1, 0
    v_mov_b32 v2, 0
    v_mov_b32 v3, 0
    v_mov_b32 v4, 0
    v_mov_b32 v5, 0
    v_mov_b32 v6, 0
    v_mov_b32 v7, 0
    v_mov_b32 v8, 0
    v_mov_b32 v9, 0
    v_mov_b32 v10, 0
    v_mov_b32 v11, 0
    v_mov_b32 v12, 0
    v_mov_b32 v13, 0
    v_mov_b32 v14, 0
    v_mov_b32 v15, 0
    v_mov_b32 v16, 0
    v_mov_b32 v17, 0
    v_mov_b32 v18, 0
    v_mov_b32 v19, 0
    v_mov_b32 v20, 0
    v_mov_b32 v21, 0
    v_mov_b32 v22, 0
    v_mov_b32 v23, 0
    v_mov_b32 v24, 0
    v_mov_b32 v25, 0
    v_mov_b32 v26, 0
    v_mov_b32 v27, 0
    v_mov_b32 v28, 0
    v_mov_b32 v29, 0
    v_mov_b32 v30, 0
    v_mov_b32 v31, 0
    v_mov_b32 v32, 0
    v_mov_b32 v33, 0
    v_mov_b32 v34, 0
    v_mov_b32 v35, 0
    v_mov_b32 v36, 0
    v_mov_b32 v37, 0
    v_mov_b32 v38, 0
    v_mov_b32 v39, 0
    v_mov_b32 v40, 0
    v_mov_b32 v41, 0
    v_mov_b32 v42, 0
    v_mov_b32 v43, 0
    v_mov_b32 v44, 0
    v_mov_b32 v45, 0
    v_mov_b32 v46, 0
    v_mov_b32 v47, 0
    v_mov_b32 v48, 0
    v_mov_b32 v49, 0
    v_mov_b32 v50, 0
    v_mov_b32 v51, 0
    v_mov_b32 v52, 0
    v_mov_b32 v53, 0
    v_mov_b32 v54, 0
    v_mov_b32 v55, 0
    v_mov_b32 v56, 0
    v_mov_b32 v57, 0
    v_mov_b32 v58, 0
    v_mov_b32 v59, 0
    v_mov_b32 v60, 0
    v_mov_b32 v61, 0
    v_mov_b32 v62, 0
    v_mov_b32 v63, 0
    v_mov_b32 v64, 0
    v_mov_b32 v65, 0
    v_mov_b32 v66, 0
    v_mov_b32 v67, 0
    v_mov_b32 v68, 0
    v_mov_b32 v69, 0
    v_mov_b32 v70, 0
    v_mov_b32 v71, 0
    v_mov_b32 v72, 0
    v_mov_b32 v73, 0
    v_mov_b32 v74, 0
    v_mov_b32 v75, 0
    v_mov_b32 v76, 0
    v_mov_b32 v77, 0
    v_mov_b32 v78, 0
    v_mov_b32 v79, 0
    v_mov_b32 v80, 0
    v_mov_b32 v81, 0
    v_mov_b32 v82, 0
    v_mov_b32 v83, 0
    v_mov_b32 v84, 0
    v_mov_b32 v85, 0
    v_mov_b32 v86, 0
    v_mov_b32 v87, 0
    v_mov_b32 v88, 0
    v_mov_b32 v89, 0
    v_mov_b32 v90, 0
    v_mov_b32 v91, 0
    v_mov_b32 v92, 0
    v_mov_b32 v93, 0
    v_mov_b32 v94, 0
    v_mov_b32 v95, 0
    v_mov_b32 v252, 0xff800000
    v_mov_b32 v253, 0
    s_mov_b32 s27, 0x3dd53b95
    s_lshl_b32 s32, s30, 10
    s_mov_b32 s28, 16
    s_add_u32 m0, s32, 0
    s_nop 0
    buffer_load_dwordx4 v240, s[8:11], s26 offen lds
    s_add_u32 m0, s32, 8192
    s_nop 0
    buffer_load_dwordx4 v241, s[8:11], s26 offen lds
    s_add_u32 m0, s32, 16384
    s_nop 0
    buffer_load_dwordx4 v242, s[8:11], s26 offen lds
    s_add_u32 s26, s26, 24576
    s_add_u32 m0, s32, 49152
    s_nop 0
    buffer_load_dwordx4 v243, s[12:15], s25 offen lds
    s_add_u32 m0, s32, 57344
    s_nop 0
    buffer_load_dwordx4 v244, s[12:15], s25 offen lds
    s_add_u32 m0, s32, 65536
    s_nop 0
    buffer_load_dwordx4 v245, s[12:15], s25 offen lds
    s_add_u32 s25, s25, 24576
    s_add_u32 m0, s32, 24576
    s_nop 0
    buffer_load_dwordx4 v240, s[8:11], s26 offen lds
    s_add_u32 m0, s32, 32768
    s_nop 0
    buffer_load_dwordx4 v241, s[8:11], s26 offen lds
    s_add_u32 m0, s32, 40960
    s_nop 0
    buffer_load_dwordx4 v242, s[8:11], s26 offen lds
    s_add_u32 s26, s26, 24576
    s_waitcnt vmcnt(3)
    s_barrier
    ds_read_b128 v[208:211], v246 offset:0
    ds_read_b128 v[212:215], v246 offset:12288
    ds_read_b128 v[216:219], v247 offset:0
    ds_read_b128 v[220:223], v247 offset:12288
    s_waitcnt lgkmcnt(3)
    v_mfma_f32_32x32x16_bf16 v[96:111], v[208:211], v[160:163], 0
    ds_read_b128 v[208:211], v248 offset:0
    s_waitcnt lgkmcnt(3)
    v_mfma_f32_32x32x16_bf16 v[112:127], v[212:215], v[160:163], 0
    ds_read_b128 v[212:215], v248 offset:12288
    s_waitcnt lgkmcnt(3)
    v_mfma_f32_32x32x16_bf16 v[96:111], v[216:219], v[164:167], v[96:111]
    ds_read_b128 v[216:219], v249 offset:0
    s_waitcnt lgkmcnt(3)
    v_mfma_f32_32x32x16_bf16 v[112:127], v[220:223], v[164:167], v[112:127]
    ds_read_b128 v[220:223], v249 offset:12288
    s_waitcnt lgkmcnt(3)
    v_mfma_f32_32x32x16_bf16 v[96:111], v[208:211], v[168:171], v[96:111]
    ds_read_b128 v[208:211], v246 offset:128
    s_waitcnt lgkmcnt(3)
    v_mfma_f32_32x32x16_bf16 v[112:127], v[212:215], v[168:171], v[112:127]
    ds_read_b128 v[212:215], v246 offset:12416
    s_waitcnt lgkmcnt(3)
    v_mfma_f32_32x32x16_bf16 v[96:111], v[216:219], v[172:175], v[96:111]
    ds_read_b128 v[216:219], v247 offset:128
    s_waitcnt lgkmcnt(3)
    v_mfma_f32_32x32x16_bf16 v[112:127], v[220:223], v[172:175], v[112:127]
    ds_read_b128 v[220:223], v247 offset:12416
    s_waitcnt lgkmcnt(3)
    v_mfma_f32_32x32x16_bf16 v[96:111], v[208:211], v[176:179], v[96:111]
    ds_read_b128 v[208:211], v248 offset:128
    s_waitcnt lgkmcnt(3)
    v_mfma_f32_32x32x16_bf16 v[112:127], v[212:215], v[176:179], v[112:127]
    ds_read_b128 v[212:215], v248 offset:12416
    s_waitcnt lgkmcnt(3)
    v_mfma_f32_32x32x16_bf16 v[96:111], v[216:219], v[180:183], v[96:111]
    ds_read_b128 v[216:219], v249 offset:128
    s_waitcnt lgkmcnt(3)
    v_mfma_f32_32x32x16_bf16 v[112:127], v[220:223], v[180:183], v[112:127]
    ds_read_b128 v[220:223], v249 offset:12416
    s_waitcnt lgkmcnt(3)
    v_mfma_f32_32x32x16_bf16 v[96:111], v[208:211], v[184:187], v[96:111]
    ds_read_b128 v[208:211], v246 offset:256
    s_waitcnt lgkmcnt(3)
    v_mfma_f32_32x32x16_bf16 v[112:127], v[212:215], v[184:187], v[112:127]
    ds_read_b128 v[212:215], v246 offset:12544
    s_waitcnt lgkmcnt(3)
    v_mfma_f32_32x32x16_bf16 v[96:111], v[216:219], v[188:191], v[96:111]
    ds_read_b128 v[216:219], v247 offset:256
    s_waitcnt lgkmcnt(3)
    v_mfma_f32_32x32x16_bf16 v[112:127], v[220:223], v[188:191], v[112:127]
    ds_read_b128 v[220:223], v247 offset:12544
    s_waitcnt lgkmcnt(3)
    v_mfma_f32_32x32x16_bf16 v[96:111], v[208:211], v[192:195], v[96:111]
    ds_read_b128 v[208:211], v248 offset:256
    s_waitcnt lgkmcnt(3)
    v_mfma_f32_32x32x16_bf16 v[112:127], v[212:215], v[192:195], v[112:127]
    ds_read_b128 v[212:215], v248 offset:12544
    s_waitcnt lgkmcnt(3)
    v_mfma_f32_32x32x16_bf16 v[96:111], v[216:219], v[196:199], v[96:111]
    ds_read_b128 v[216:219], v249 offset:256
    s_waitcnt lgkmcnt(3)
    v_mfma_f32_32x32x16_bf16 v[112:127], v[220:223], v[196:199], v[112:127]
    ds_read_b128 v[220:223], v249 offset:12544
    s_waitcnt lgkmcnt(3)
    v_mfma_f32_32x32x16_bf16 v[96:111], v[208:211], v[200:203], v[96:111]
    s_waitcnt lgkmcnt(2)
    v_mfma_f32_32x32x16_bf16 v[112:127], v[212:215], v[200:203], v[112:127]
    s_waitcnt lgkmcnt(1)
    v_mfma_f32_32x32x16_bf16 v[96:111], v[216:219], v[204:207], v[96:111]
    s_waitcnt lgkmcnt(0)
    v_mfma_f32_32x32x16_bf16 v[112:127], v[220:223], v[204:207], v[112:127]
    s_nop 15
    v_max3_f32 v230, v96, v97, v98
    v_max3_f32 v230, v230, v99, v100
    v_max3_f32 v230, v230, v101, v102
    v_max3_f32 v230, v230, v103, v104
    v_max3_f32 v230, v230, v105, v106
    v_max3_f32 v230, v230, v107, v108
    v_max3_f32 v230, v230, v109, v110
    v_max3_f32 v230, v230, v111, v112
    v_max3_f32 v230, v230, v113, v114
    v_max3_f32 v230, v230, v115, v116
    v_max3_f32 v230, v230, v117, v118
    v_max3_f32 v230, v230, v119, v120
    v_max3_f32 v230, v230, v121, v122
    v_max3_f32 v230, v230, v123, v124
    v_max3_f32 v230, v230, v125, v126
    v_max_f32 v230, v230, v127
    v_mov_b32 v231, v230
    s_nop 1
    v_permlane32_swap_b32 v230, v231
    s_nop 1
    v_max3_f32 v230, v230, v231, v252
    v_sub_f32 v231, v252, v230
    v_mul_f32 v231, s27, v231
    v_exp_f32 v231, v231
    v_mov_b32 v252, v230
    v_mul_f32 v232, s27, v230
    v_mul_f32 v253, v253, v231
    v_cmp_neq_f32 vcc, 1.0, v231
L_at_loop:
    s_waitcnt vmcnt(0)
    s_barrier
    s_add_u32 m0, s32, 0
    s_nop 0
    buffer_load_dwordx4 v240, s[8:11], s26 offen lds
    s_add_u32 m0, s32, 8192
    s_nop 0
    buffer_load_dwordx4 v241, s[8:11], s26 offen lds
    s_add_u32 m0, s32, 16384
    s_nop 0
    buffer_load_dwordx4 v242, s[8:11], s26 offen lds
    s_add_u32 s26, s26, 24576
    s_add_u32 m0, s32, 73728
    s_nop 0
    buffer_load_dwordx4 v243, s[12:15], s25 offen lds
    s_add_u32 m0, s32, 81920
    s_nop 0
    buffer_load_dwordx4 v244, s[12:15], s25 offen lds
    s_add_u32 m0, s32, 90112
    s_nop 0
    buffer_load_dwordx4 v245, s[12:15], s25 offen lds
    s_add_u32 s25, s25, 24576
    ds_read_b128 v[208:211], v246 offset:24576
    ds_read_b128 v[212:215], v246 offset:36864
    ds_read_b128 v[216:219], v247 offset:24576
    ds_read_b128 v[220:223], v247 offset:36864
    s_waitcnt lgkmcnt(3)
    v_mfma_f32_32x32x16_bf16 v[128:143], v[208:211], v[160:163], 0
    v_fma_f32 v96, v96, s27, -v232
    v_exp_f32 v96, v96
    v_fma_f32 v97, v97, s27, -v232
    v_exp_f32 v97, v97
    ds_read_b128 v[208:211], v248 offset:24576
    s_waitcnt lgkmcnt(3)
    v_mfma_f32_32x32x16_bf16 v[144:159], v[212:215], v[160:163], 0
    v_fma_f32 v98, v98, s27, -v232
    v_exp_f32 v98, v98
    v_fma_f32 v99, v99, s27, -v232
    v_exp_f32 v99, v99
    v_fma_f32 v100, v100, s27, -v232
    ds_read_b128 v[212:215], v248 offset:36864
    s_waitcnt lgkmcnt(3)
    v_mfma_f32_32x32x16_bf16 v[128:143], v[216:219], v[164:167], v[128:143]
    v_exp_f32 v100, v100
    v_fma_f32 v101, v101, s27, -v232
    v_exp_f32 v101, v101
    v_fma_f32 v102, v102, s27, -v232
    v_exp_f32 v102, v102
    ds_read_b128 v[216:219], v249 offset:24576
    s_waitcnt lgkmcnt(3)
    v_mfma_f32_32x32x16_bf16 v[144:159], v[220:223], v[164:167], v[144:159]
    v_fma_f32 v103, v103, s27, -v232
    v_exp_f32 v103, v103
    v_fma_f32 v104, v104, s27, -v232
    v_exp_f32 v104, v104
    ds_read_b128 v[220:223], v249 offset:36864
    s_waitcnt lgkmcnt(3)
    v_mfma_f32_32x32x16_bf16 v[128:143], v[208:211], v[168:171], v[128:143]
    v_fma_f32 v105, v105, s27, -v232
    v_exp_f32 v105, v105
    v_fma_f32 v106, v106, s27, -v232
    v_exp_f32 v106, v106
    v_fma_f32 v107, v107, s27, -v232
    ds_read_b128 v[208:211], v246 offset:24704
    s_waitcnt lgkmcnt(3)
    v_mfma_f32_32x32x16_bf16 v[144:159], v[212:215], v[168:171], v[144:159]
    v_exp_f32 v107, v107
    v_fma_f32 v108, v108, s27, -v232
    v_exp_f32 v108, v108
    v_fma_f32 v109, v109, s27, -v232
    v_exp_f32 v109, v109
    ds_read_b128 v[212:215], v246 offset:36992
    s_waitcnt lgkmcnt(3)
    v_mfma_f32_32x32x16_bf16 v[128:143], v[216:219], v[172:175], v[128:143]
    v_fma_f32 v110, v110, s27, -v232
    v_exp_f32 v110, v110
    v_fma_f32 v111, v111, s27, -v232
    v_exp_f32 v111, v111
    ds_read_b128 v[216:219], v247 offset:24704
    s_waitcnt lgkmcnt(3)
    v_mfma_f32_32x32x16_bf16 v[144:159], v[220:223], v[172:175], v[144:159]
    v_fma_f32 v112, v112, s27, -v232
    v_exp_f32 v112, v112
    v_fma_f32 v113, v113, s27, -v232
    v_exp_f32 v113, v113
    v_fma_f32 v114, v114, s27, -v232
    ds_read_b128 v[220:223], v247 offset:36992
    s_waitcnt lgkmcnt(3)
    v_mfma_f32_32x32x16_bf16 v[128:143], v[208:211], v[176:179], v[128:143]
    v_exp_f32 v114, v114
    v_fma_f32 v115, v115, s27, -v232
    v_exp_f32 v115, v115
    v_fma_f32 v116, v116, s27, -v232
    v_exp_f32 v116, v116
    ds_read_b128 v[208:211], v248 offset:24704
    s_waitcnt lgkmcnt(3)
    v_mfma_f32_32x32x16_bf16 v[144:159], v[212:215], v[176:179], v[144:159]
    v_fma_f32 v117, v117, s27, -v232
    v_exp_f32 v117, v117
    v_fma_f32 v118, v118, s27, -v232
    v_exp_f32 v118, v118
    ds_read_b128 v[212:215], v248 offset:36992
    s_waitcnt lgkmcnt(3)
    v_mfma_f32_32x32x16_bf16 v[128:143], v[216:219], v[180:183], v[128:143]
    v_fma_f32 v119, v119, s27, -v232
    v_exp_f32 v119, v119
    v_fma_f32 v120, v120, s27, -v232
    v_exp_f32 v120, v120
    v_fma_f32 v121, v121, s27, -v232
    ds_read_b128 v[216:219], v249 offset:24704
    s_waitcnt lgkmcnt(3)
    v_mfma_f32_32x32x16_bf16 v[144:159], v[220:223], v[180:183], v[144:159]
    v_exp_f32 v121, v121
    v_fma_f32 v122, v122, s27, -v232
    v_exp_f32 v122, v122
    v_fma_f32 v123, v123, s27, -v232
    v_exp_f32 v123, v123
    ds_read_b128 v[220:223], v249 offset:36992
    s_waitcnt lgkmcnt(3)
    v_mfma_f32_32x32x16_bf16 v[128:143], v[208:211], v[184:187], v[128:143]
    v_fma_f32 v124, v124, s27, -v232
    v_exp_f32 v124, v124
    v_fma_f32 v125, v125, s27, -v232
    v_exp_f32 v125, v125
    ds_read_b128 v[208:211], v246 offset:24832
    s_waitcnt lgkmcnt(3)
    v_mfma_f32_32x32x16_bf16 v[144:159], v[212:215], v[184:187], v[144:159]
    v_fma_f32 v126, v126, s27, -v232
    v_exp_f32 v126, v126
    v_fma_f32 v127, v127, s27, -v232
    v_exp_f32 v127, v127
    v_add_f32 v253, v253, v96
    ds_read_b128 v[212:215], v246 offset:37120
    s_waitcnt lgkmcnt(3)
    v_mfma_f32_32x32x16_bf16 v[128:143], v[216:219], v[188:191], v[128:143]
    v_add_f32 v253, v253, v97
    v_cvt_pk_bf16_f32 v96, v96, v97
    v_add_f32 v253, v253, v98
    v_add_f32 v253, v253, v99
    v_cvt_pk_bf16_f32 v97, v98, v99
    ds_read_b128 v[216:219], v247 offset:24832
    s_waitcnt lgkmcnt(3)
    v_mfma_f32_32x32x16_bf16 v[144:159], v[220:223], v[188:191], v[144:159]
    v_add_f32 v253, v253, v100
    v_add_f32 v253, v253, v101
    v_cvt_pk_bf16_f32 v98, v100, v101
    v_add_f32 v253, v253, v102
    ds_read_b128 v[220:223], v247 offset:37120
    s_waitcnt lgkmcnt(3)
    v_mfma_f32_32x32x16_bf16 v[128:143], v[208:211], v[192:195], v[128:143]
    v_add_f32 v253, v253, v103
    v_cvt_pk_bf16_f32 v99, v102, v103
    v_add_f32 v253, v253, v104
    v_add_f32 v253, v253, v105
    v_cvt_pk_bf16_f32 v100, v104, v105
    ds_read_b128 v[208:211], v248 offset:24832
    s_waitcnt lgkmcnt(3)
    v_mfma_f32_32x32x16_bf16 v[144:159], v[212:215], v[192:195], v[144:159]
    v_add_f32 v253, v253, v106
    v_add_f32 v253, v253, v107
    v_cvt_pk_bf16_f32 v101, v106, v107
    v_add_f32 v253, v253, v108
    v_add_f32 v253, v253, v109
    ds_read_b128 v[212:215], v248 offset:37120
    s_waitcnt lgkmcnt(3)
    v_mfma_f32_32x32x16_bf16 v[128:143], v[216:219], v[196:199], v[128:143]
    v_cvt_pk_bf16_f32 v102, v108, v109
    v_add_f32 v253, v253, v110
    v_add_f32 v253, v253, v111
    v_cvt_pk_bf16_f32 v103, v110, v111
    ds_read_b128 v[216:219], v249 offset:24832
    s_waitcnt lgkmcnt(3)
    v_mfma_f32_32x32x16_bf16 v[144:159], v[220:223], v[196:199], v[144:159]
    v_add_f32 v253, v253, v112
    v_add_f32 v253, v253, v113
    v_cvt_pk_bf16_f32 v104, v112, v113
    v_add_f32 v253, v253, v114
    v_add_f32 v253, v253, v115
    ds_read_b128 v[220:223], v249 offset:37120
    s_waitcnt lgkmcnt(3)
    v_mfma_f32_32x32x16_bf16 v[128:143], v[208:211], v[200:203], v[128:143]
    v_cvt_pk_bf16_f32 v105, v114, v115
    v_add_f32 v253, v253, v116
    v_add_f32 v253, v253, v117
    v_cvt_pk_bf16_f32 v106, v116, v117
    v_add_f32 v253, v253, v118
    s_waitcnt lgkmcnt(2)
    v_mfma_f32_32x32x16_bf16 v[144:159], v[212:215], v[200:203], v[144:159]
    v_add_f32 v253, v253, v119
    v_cvt_pk_bf16_f32 v107, v118, v119
    v_add_f32 v253, v253, v120
    v_add_f32 v253, v253, v121
    s_waitcnt lgkmcnt(1)
    v_mfma_f32_32x32x16_bf16 v[128:143], v[216:219], v[204:207], v[128:143]
    v_cvt_pk_bf16_f32 v108, v120, v121
    v_add_f32 v253, v253, v122
    v_add_f32 v253, v253, v123
    v_cvt_pk_bf16_f32 v109, v122, v123
    v_add_f32 v253, v253, v124
    s_waitcnt lgkmcnt(0)
    v_mfma_f32_32x32x16_bf16 v[144:159], v[220:223], v[204:207], v[144:159]
    v_add_f32 v253, v253, v125
    v_cvt_pk_bf16_f32 v110, v124, v125
    v_add_f32 v253, v253, v126
    v_add_f32 v253, v253, v127
    v_cvt_pk_bf16_f32 v111, v126, v127
    s_cbranch_vccz L_at_nors00
    v_mul_f32 v0, v0, v231
    v_mul_f32 v1, v1, v231
    v_mul_f32 v2, v2, v231
    v_mul_f32 v3, v3, v231
    v_mul_f32 v4, v4, v231
    v_mul_f32 v5, v5, v231
    v_mul_f32 v6, v6, v231
    v_mul_f32 v7, v7, v231
    v_mul_f32 v8, v8, v231
    v_mul_f32 v9, v9, v231
    v_mul_f32 v10, v10, v231
    v_mul_f32 v11, v11, v231
    v_mul_f32 v12, v12, v231
    v_mul_f32 v13, v13, v231
    v_mul_f32 v14, v14, v231
    v_mul_f32 v15, v15, v231
    v_mul_f32 v16, v16, v231
    v_mul_f32 v17, v17, v231
    v_mul_f32 v18, v18, v231
    v_mul_f32 v19, v19, v231
    v_mul_f32 v20, v20, v231
    v_mul_f32 v21, v21, v231
    v_mul_f32 v22, v22, v231
    v_mul_f32 v23, v23, v231
    v_mul_f32 v24, v24, v231
    v_mul_f32 v25, v25, v231
    v_mul_f32 v26, v26, v231
    v_mul_f32 v27, v27, v231
    v_mul_f32 v28, v28, v231
    v_mul_f32 v29, v29, v231
    v_mul_f32 v30, v30, v231
    v_mul_f32 v31, v31, v231
    v_mul_f32 v32, v32, v231
    v_mul_f32 v33, v33, v231
    v_mul_f32 v34, v34, v231
    v_mul_f32 v35, v35, v231
    v_mul_f32 v36, v36, v231
    v_mul_f32 v37, v37, v231
    v_mul_f32 v38, v38, v231
    v_mul_f32 v39, v39, v231
    v_mul_f32 v40, v40, v231
    v_mul_f32 v41, v41, v231
    v_mul_f32 v42, v42, v231
    v_mul_f32 v43, v43, v231
    v_mul_f32 v44, v44, v231
    v_mul_f32 v45, v45, v231
    v_mul_f32 v46, v46, v231
    v_mul_f32 v47, v47, v231
    v_mul_f32 v48, v48, v231
    v_mul_f32 v49, v49, v231
    v_mul_f32 v50, v50, v231
    v_mul_f32 v51, v51, v231
    v_mul_f32 v52, v52, v231
    v_mul_f32 v53, v53, v231
    v_mul_f32 v54, v54, v231
    v_mul_f32 v55, v55, v231
    v_mul_f32 v56, v56, v231
    v_mul_f32 v57, v57, v231
    v_mul_f32 v58, v58, v231
    v_mul_f32 v59, v59, v231
    v_mul_f32 v60, v60, v231
    v_mul_f32 v61, v61, v231
    v_mul_f32 v62, v62, v231
    v_mul_f32 v63, v63, v231
    v_mul_f32 v64, v64, v231
    v_mul_f32 v65, v65, v231
    v_mul_f32 v66, v66, v231
    v_mul_f32 v67, v67, v231
    v_mul_f32 v68, v68, v231
    v_mul_f32 v69, v69, v231
    v_mul_f32 v70, v70, v231
    v_mul_f32 v71, v71, v231
    v_mul_f32 v72, v72, v231
    v_mul_f32 v73, v73, v231
    v_mul_f32 v74, v74, v231
    v_mul_f32 v75, v75, v231
    v_mul_f32 v76, v76, v231
    v_mul_f32 v77, v77, v231
    v_mul_f32 v78, v78, v231
    v_mul_f32 v79, v79, v231
    v_mul_f32 v80, v80, v231
    v_mul_f32 v81, v81, v231
    v_mul_f32 v82, v82, v231
    v_mul_f32 v83, v83, v231
    v_mul_f32 v84, v84, v231
    v_mul_f32 v85, v85, v231
    v_mul_f32 v86, v86, v231
    v_mul_f32 v87, v87, v231
    v_mul_f32 v88, v88, v231
    v_mul_f32 v89, v89, v231
    v_mul_f32 v90, v90, v231
    v_mul_f32 v91, v91, v231
    v_mul_f32 v92, v92, v231
    v_mul_f32 v93, v93, v231
    v_mul_f32 v94, v94, v231
    v_mul_f32 v95, v95, v231
L_at_nors00:
    ds_read_b64_tr_b16 v[208:209], v250 offset:0
    ds_read_b64_tr_b16 v[210:211], v250 offset:3072
    ds_read_b64_tr_b16 v[212:213], v251 offset:0
    ds_read_b64_tr_b16 v[214:215], v251 offset:3072
    ds_read_b64_tr_b16 v[216:217], v250 offset:128
    ds_read_b64_tr_b16 v[218:219], v250 offset:3200
    ds_read_b64_tr_b16 v[220:221], v251 offset:128
    ds_read_b64_tr_b16 v[222:223], v251 offset:3200
    s_waitcnt lgkmcnt(6)
    v_mfma_f32_32x32x16_bf16 v[0:15], v[208:211], v[96:99], v[0:15]
    s_nop 7
    ds_read_b64_tr_b16 v[208:209], v250 offset:256
    ds_read_b64_tr_b16 v[210:211], v250 offset:3328
    s_waitcnt lgkmcnt(6)
    v_mfma_f32_32x32x16_bf16 v[16:31], v[212:215], v[96:99], v[16:31]
    v_max3_f32 v230, v128, v129, v130
    ds_read_b64_tr_b16 v[212:213], v251 offset:256
    ds_read_b64_tr_b16 v[214:215], v251 offset:3328
    s_waitcnt lgkmcnt(6)
    v_mfma_f32_32x32x16_bf16 v[32:47], v[216:219], v[96:99], v[32:47]
    v_max3_f32 v230, v230, v131, v132
    ds_read_b64_tr_b16 v[216:217], v250 offset:6144
    ds_read_b64_tr_b16 v[218:219], v250 offset:9216
    s_waitcnt lgkmcnt(6)
    v_mfma_f32_32x32x16_bf16 v[48:63], v[220:223], v[96:99], v[48:63]
    v_max3_f32 v230, v230, v133, v134
    ds_read_b64_tr_b16 v[220:221], v251 offset:6144
    ds_read_b64_tr_b16 v[222:223], v251 offset:9216
    s_waitcnt lgkmcnt(6)
    v_mfma_f32_32x32x16_bf16 v[64:79], v[208:211], v[96:99], v[64:79]
    v_max3_f32 v230, v230, v135, v136
    v_max3_f32 v230, v230, v137, v138
    ds_read_b64_tr_b16 v[208:209], v250 offset:6272
    ds_read_b64_tr_b16 v[210:211], v250 offset:9344
    s_waitcnt lgkmcnt(6)
    v_mfma_f32_32x32x16_bf16 v[80:95], v[212:215], v[96:99], v[80:95]
    v_max3_f32 v230, v230, v139, v140
    ds_read_b64_tr_b16 v[212:213], v251 offset:6272
    ds_read_b64_tr_b16 v[214:215], v251 offset:9344
    s_waitcnt lgkmcnt(6)
    v_mfma_f32_32x32x16_bf16 v[0:15], v[216:219], v[100:103], v[0:15]
    v_max3_f32 v230, v230, v141, v142
    ds_read_b64_tr_b16 v[216:217], v250 offset:6400
    ds_read_b64_tr_b16 v[218:219], v250 offset:9472
    s_waitcnt lgkmcnt(6)
    v_mfma_f32_32x32x16_bf16 v[16:31], v[220:223], v[100:103], v[16:31]
    v_max3_f32 v230, v230, v143, v144
    ds_read_b64_tr_b16 v[220:221], v251 offset:6400
    ds_read_b64_tr_b16 v[222:223], v251 offset:9472
    s_waitcnt lgkmcnt(6)
    v_mfma_f32_32x32x16_bf16 v[32:47], v[208:211], v[100:103], v[32:47]
    v_max3_f32 v230, v230, v145, v146
    ds_read_b64_tr_b16 v[208:209], v250 offset:12288
    ds_read_b64_tr_b16 v[210:211], v250 offset:15360
    s_waitcnt lgkmcnt(6)
    v_mfma_f32_32x32x16_bf16 v[48:63], v[212:215], v[100:103], v[48:63]
    v_max3_f32 v230, v230, v147, v148
    v_max3_f32 v230, v230, v149, v150
    ds_read_b64_tr_b16 v[212:213], v251 offset:12288
    ds_read_b64_tr_b16 v[214:215], v251 offset:15360
    s_waitcnt lgkmcnt(6)
    v_mfma_f32_32x32x16_bf16 v[64:79], v[216:219], v[100:103], v[64:79]
    v_max3_f32 v230, v230, v151, v152
    ds_read_b64_tr_b16 v[216:217], v250 offset:12416
    ds_read_b64_tr_b16 v[218:219], v250 offset:15488
    s_waitcnt lgkmcnt(6)
    v_mfma_f32_32x32x16_bf16 v[80:95], v[220:223], v[100:103], v[80:95]
    v_max3_f32 v230, v230, v153, v154
    ds_read_b64_tr_b16 v[220:221], v251 offset:12416
    ds_read_b64_tr_b16 v[222:223], v251 offset:15488
    s_waitcnt lgkmcnt(6)
    v_mfma_f32_32x32x16_bf16 v[0:15], v[208:211], v[104:107], v[0:15]
    v_max3_f32 v230, v230, v155, v156
    ds_read_b64_tr_b16 v[208:209], v250 offset:12544
    ds_read_b64_tr_b16 v[210:211], v250 offset:15616
    s_waitcnt lgkmcnt(6)
    v_mfma_f32_32x32x16_bf16 v[16:31], v[212:215], v[104:107], v[16:31]
    v_max3_f32 v230, v230, v157, v158
    ds_read_b64_tr_b16 v[212:213], v251 offset:12544
    ds_read_b64_tr_b16 v[214:215], v251 offset:15616
    s_waitcnt lgkmcnt(6)
    v_mfma_f32_32x32x16_bf16 v[32:47], v[216:219], v[104:107], v[32:47]
    v_max_f32 v230, v230, v159
    v_mov_b32 v231, v230
    ds_read_b64_tr_b16 v[216:217], v250 offset:18432
    ds_read_b64_tr_b16 v[218:219], v250 offset:21504
    s_waitcnt lgkmcnt(6)
    v_mfma_f32_32x32x16_bf16 v[48:63], v[220:223], v[104:107], v[48:63]
    s_nop 1
    ds_read_b64_tr_b16 v[220:221], v251 offset:18432
    ds_read_b64_tr_b16 v[222:223], v251 offset:21504
    s_waitcnt lgkmcnt(6)
    v_mfma_f32_32x32x16_bf16 v[64:79], v[208:211], v[104:107], v[64:79]
    v_permlane32_swap_b32 v230, v231
    ds_read_b64_tr_b16 v[208:209], v250 offset:18560
    ds_read_b64_tr_b16 v[210:211], v250 offset:21632
    s_waitcnt lgkmcnt(6)
    v_mfma_f32_32x32x16_bf16 v[80:95], v[212:215], v[104:107], v[80:95]
    s_nop 1
    ds_read_b64_tr_b16 v[212:213], v251 offset:18560
    ds_read_b64_tr_b16 v[214:215], v251 offset:21632
    s_waitcnt lgkmcnt(6)
    v_mfma_f32_32x32x16_bf16 v[0:15], v[216:219], v[108:111], v[0:15]
    v_max3_f32 v230, v230, v231, v252
    ds_read_b64_tr_b16 v[216:217], v250 offset:18688
    ds_read_b64_tr_b16 v[218:219], v250 offset:21760
    s_waitcnt lgkmcnt(6)
    v_mfma_f32_32x32x16_bf16 v[16:31], v[220:223], v[108:111], v[16:31]
    v_sub_f32 v231, v252, v230
    v_mul_f32 v231, s27, v231
    ds_read_b64_tr_b16 v[220:221], v251 offset:18688
    ds_read_b64_tr_b16 v[222:223], v251 offset:21760
    s_waitcnt lgkmcnt(6)
    v_mfma_f32_32x32x16_bf16 v[32:47], v[208:211], v[108:111], v[32:47]
    v_exp_f32 v231, v231
    s_waitcnt lgkmcnt(4)
    v_mfma_f32_32x32x16_bf16 v[48:63], v[212:215], v[108:111], v[48:63]
    v_mov_b32 v252, v230
    s_waitcnt lgkmcnt(2)
    v_mfma_f32_32x32x16_bf16 v[64:79], v[216:219], v[108:111], v[64:79]
    v_mul_f32 v232, s27, v230
    s_waitcnt lgkmcnt(0)
    v_mfma_f32_32x32x16_bf16 v[80:95], v[220:223], v[108:111], v[80:95]
    v_mul_f32 v253, v253, v231
    v_cmp_neq_f32 vcc, 1.0, v231
    s_cmp_eq_u32 s28, 1
    s_cbranch_scc1 L_at_last
    s_waitcnt vmcnt(0)
    s_barrier
    s_add_u32 m0, s32, 24576
    s_nop 0
    buffer_load_dwordx4 v240, s[8:11], s26 offen lds
    s_add_u32 m0, s32, 32768
    s_nop 0
    buffer_load_dwordx4 v241, s[8:11], s26 offen lds
    s_add_u32 m0, s32, 40960
    s_nop 0
    buffer_load_dwordx4 v242, s[8:11], s26 offen lds
    s_add_u32 s26, s26, 24576
    s_add_u32 m0, s32, 49152
    s_nop 0
    buffer_load_dwordx4 v243, s[12:15], s25 offen lds
    s_add_u32 m0, s32, 57344
    s_nop 0
    buffer_load_dwordx4 v244, s[12:15], s25 offen lds
    s_add_u32 m0, s32, 65536
    s_nop 0
    buffer_load_dwordx4 v245, s[12:15], s25 offen lds
    s_add_u32 s25, s25, 24576
    ds_read_b128 v[208:211], v246 offset:0
    ds_read_b128 v[212:215], v246 offset:12288
    ds_read_b128 v[216:219], v247 offset:0
    ds_read_b128 v[220:223], v247 offset:12288
    s_waitcnt lgkmcnt(3)
    v_mfma_f32_32x32x16_bf16 v[96:111], v[208:211], v[160:163], 0
    v_fma_f32 v128, v128, s27, -v232
    v_exp_f32 v128, v128
    v_fma_f32 v129, v129, s27, -v232
    v_exp_f32 v129, v129
    ds_read_b128 v[208:211], v248 offset:0
    s_waitcnt lgkmcnt(3)
    v_mfma_f32_32x32x16_bf16 v[112:127], v[212:215], v[160:163], 0
    v_fma_f32 v130, v130, s27, -v232
    v_exp_f32 v130, v130
    v_fma_f32 v131, v131, s27, -v232
    v_exp_f32 v131, v131
    v_fma_f32 v132, v132, s27, -v232
    ds_read_b128 v[212:215], v248 offset:12288
    s_waitcnt lgkmcnt(3)
    v_mfma_f32_32x32x16_bf16 v[96:111], v[216:219], v[164:167], v[96:111]
    v_exp_f32 v132, v132
    v_fma_f32 v133, v133, s27, -v232
    v_exp_f32 v133, v133
    v_fma_f32 v134, v134, s27, -v232
    v_exp_f32 v134, v134
    ds_read_b128 v[216:219], v249 offset:0
    s_waitcnt lgkmcnt(3)
    v_mfma_f32_32x32x16_bf16 v[112:127], v[220:223], v[164:167], v[112:127]
    v_fma_f32 v135, v135, s27, -v232
    v_exp_f32 v135, v135
    v_fma_f32 v136, v136, s27, -v232
    v_exp_f32 v136, v136
    ds_read_b128 v[220:223], v249 offset:12288
    s_waitcnt lgkmcnt(3)
    v_mfma_f32_32x32x16_bf16 v[96:111], v[208:211], v[168:171], v[96:111]
    v_fma_f32 v137, v137, s27, -v232
    v_exp_f32 v137, v137
    v_fma_f32 v138, v138, s27, -v232
    v_exp_f32 v138, v138
    v_fma_f32 v139, v139, s27, -v232
    ds_read_b128 v[208:211], v246 offset:128
    s_waitcnt lgkmcnt(3)
    v_mfma_f32_32x32x16_bf16 v[112:127], v[212:215], v[168:171], v[112:127]
    v_exp_f32 v139, v139
    v_fma_f32 v140, v140, s27, -v232
    v_exp_f32 v140, v140
    v_fma_f32 v141, v141, s27, -v232
    v_exp_f32 v141, v141
    ds_read_b128 v[212:215], v246 offset:12416
    s_waitcnt lgkmcnt(3)
    v_mfma_f32_32x32x16_bf16 v[96:111], v[216:219], v[172:175], v[96:111]
    v_fma_f32 v142, v142, s27, -v232
    v_exp_f32 v142, v142
    v_fma_f32 v143, v143, s27, -v232
    v_exp_f32 v143, v143
    ds_read_b128 v[216:219], v247 offset:128
    s_waitcnt lgkmcnt(3)
    v_mfma_f32_32x32x16_bf16 v[112:127], v[220:223], v[172:175], v[112:127]
    v_fma_f32 v144, v144, s27, -v232
    v_exp_f32 v144, v144
    v_fma_f32 v145, v145, s27, -v232
    v_exp_f32 v145, v145
    v_fma_f32 v146, v146, s27, -v232
    ds_read_b128 v[220:223], v247 offset:12416
    s_waitcnt lgkmcnt(3)
    v_mfma_f32_32x32x16_bf16 v[96:111], v[208:211], v[176:179], v[96:111]
    v_exp_f32 v146, v146
    v_fma_f32 v147, v147, s27, -v232
    v_exp_f32 v147, v147
    v_fma_f32 v148, v148, s27, -v232
    v_exp_f32 v148, v148
    ds_read_b128 v[208:211], v248 offset:128
    s_waitcnt lgkmcnt(3)
    v_mfma_f32_32x32x16_bf16 v[112:127], v[212:215], v[176:179], v[112:127]
    v_fma_f32 v149, v149, s27, -v232
    v_exp_f32 v149, v149
    v_fma_f32 v150, v150, s27, -v232
    v_exp_f32 v150, v150
    ds_read_b128 v[212:215], v248 offset:12416
    s_waitcnt lgkmcnt(3)
    v_mfma_f32_32x32x16_bf16 v[96:111], v[216:219], v[180:183], v[96:111]
    v_fma_f32 v151, v151, s27, -v232
    v_exp_f32 v151, v151
    v_fma_f32 v152, v152, s27, -v232
    v_exp_f32 v152, v152
    v_fma_f32 v153, v153, s27, -v232
    ds_read_b128 v[216:219], v249 offset:128
    s_waitcnt lgkmcnt(3)
    v_mfma_f32_32x32x16_bf16 v[112:127], v[220:223], v[180:183], v[112:127]
    v_exp_f32 v153, v153
    v_fma_f32 v154, v154, s27, -v232
    v_exp_f32 v154, v154
    v_fma_f32 v155, v155, s27, -v232
    v_exp_f32 v155, v155
    ds_read_b128 v[220:223], v249 offset:12416
    s_waitcnt lgkmcnt(3)
    v_mfma_f32_32x32x16_bf16 v[96:111], v[208:211], v[184:187], v[96:111]
    v_fma_f32 v156, v156, s27, -v232
    v_exp_f32 v156, v156
    v_fma_f32 v157, v157, s27, -v232
    v_exp_f32 v157, v157
    ds_read_b128 v[208:211], v246 offset:256
    s_waitcnt lgkmcnt(3)
    v_mfma_f32_32x32x16_bf16 v[112:127], v[212:215], v[184:187], v[112:127]
    v_fma_f32 v158, v158, s27, -v232
    v_exp_f32 v158, v158
    v_fma_f32 v159, v159, s27, -v232
    v_exp_f32 v159, v159
    v_add_f32 v253, v253, v128
    ds_read_b128 v[212:215], v246 offset:12544
    s_waitcnt lgkmcnt(3)
    v_mfma_f32_32x32x16_bf16 v[96:111], v[216:219], v[188:191], v[96:111]
    v_add_f32 v253, v253, v129
    v_cvt_pk_bf16_f32 v128, v128, v129
    v_add_f32 v253, v253, v130
    v_add_f32 v253, v253, v131
    v_cvt_pk_bf16_f32 v129, v130, v131
    ds_read_b128 v[216:219], v247 offset:256
    s_waitcnt lgkmcnt(3)
    v_mfma_f32_32x32x16_bf16 v[112:127], v[220:223], v[188:191], v[112:127]
    v_add_f32 v253, v253, v132
    v_add_f32 v253, v253, v133
    v_cvt_pk_bf16_f32 v130, v132, v133
    v_add_f32 v253, v253, v134
    ds_read_b128 v[220:223], v247 offset:12544
    s_waitcnt lgkmcnt(3)
    v_mfma_f32_32x32x16_bf16 v[96:111], v[208:211], v[192:195], v[96:111]
    v_add_f32 v253, v253, v135
    v_cvt_pk_bf16_f32 v131, v134, v135
    v_add_f32 v253, v253, v136
    v_add_f32 v253, v253, v137
    v_cvt_pk_bf16_f32 v132, v136, v137
    ds_read_b128 v[208:211], v248 offset:256
    s_waitcnt lgkmcnt(3)
    v_mfma_f32_32x32x16_bf16 v[112:127], v[212:215], v[192:195], v[112:127]
    v_add_f32 v253, v253, v138
    v_add_f32 v253, v253, v139
    v_cvt_pk_bf16_f32 v133, v138, v139
    v_add_f32 v253, v253, v140
    v_add_f32 v253, v253, v141
    ds_read_b128 v[212:215], v248 offset:12544
    s_waitcnt lgkmcnt(3)
    v_mfma_f32_32x32x16_bf16 v[96:111], v[216:219], v[196:199], v[96:111]
    v_cvt_pk_bf16_f32 v134, v140, v141
    v_add_f32 v253, v253, v142
    v_add_f32 v253, v253, v143
    v_cvt_pk_bf16_f32 v135, v142, v143
    ds_read_b128 v[216:219], v249 offset:256
    s_waitcnt lgkmcnt(3)
    v_mfma_f32_32x32x16_bf16 v[112:127], v[220:223], v[196:199], v[112:127]
    v_add_f32 v253, v253, v144
    v_add_f32 v253, v253, v145
    v_cvt_pk_bf16_f32 v136, v144, v145
    v_add_f32 v253, v253, v146
    v_add_f32 v253, v253, v147
    ds_read_b128 v[220:223], v249 offset:12544
    s_waitcnt lgkmcnt(3)
    v_mfma_f32_32x32x16_bf16 v[96:111], v[208:211], v[200:203], v[96:111]
    v_cvt_pk_bf16_f32 v137, v146, v147
    v_add_f32 v253, v253, v148
    v_add_f32 v253, v253, v149
    v_cvt_pk_bf16_f32 v138, v148, v149
    v_add_f32 v253, v253, v150
    s_waitcnt lgkmcnt(2)
    v_mfma_f32_32x32x16_bf16 v[112:127], v[212:215], v[200:203], v[112:127]
    v_add_f32 v253, v253, v151
    v_cvt_pk_bf16_f32 v139, v150, v151
    v_add_f32 v253, v253, v152
    v_add_f32 v253, v253, v153
    s_waitcnt lgkmcnt(1)
    v_mfma_f32_32x32x16_bf16 v[96:111], v[216:219], v[204:207], v[96:111]
    v_cvt_pk_bf16_f32 v140, v152, v153
    v_add_f32 v253, v253, v154
    v_add_f32 v253, v253, v155
    v_cvt_pk_bf16_f32 v141, v154, v155
    v_add_f32 v253, v253, v156
    s_waitcnt lgkmcnt(0)
    v_mfma_f32_32x32x16_bf16 v[112:127], v[220:223], v[204:207], v[112:127]
    v_add_f32 v253, v253, v157
    v_cvt_pk_bf16_f32 v142, v156, v157
    v_add_f32 v253, v253, v158
    v_add_f32 v253, v253, v159
    v_cvt_pk_bf16_f32 v143, v158, v159
    s_cbranch_vccz L_at_nors10
    v_mul_f32 v0, v0, v231
    v_mul_f32 v1, v1, v231
    v_mul_f32 v2, v2, v231
    v_mul_f32 v3, v3, v231
    v_mul_f32 v4, v4, v231
    v_mul_f32 v5, v5, v231
    v_mul_f32 v6, v6, v231
    v_mul_f32 v7, v7, v231
    v_mul_f32 v8, v8, v231
    v_mul_f32 v9, v9, v231
    v_mul_f32 v10, v10, v231
    v_mul_f32 v11, v11, v231
    v_mul_f32 v12, v12, v231
    v_mul_f32 v13, v13, v231
    v_mul_f32 v14, v14, v231
    v_mul_f32 v15, v15, v231
    v_mul_f32 v16, v16, v231
    v_mul_f32 v17, v17, v231
    v_mul_f32 v18, v18, v231
    v_mul_f32 v19, v19, v231
    v_mul_f32 v20, v20, v231
    v_mul_f32 v21, v21, v231
    v_mul_f32 v22, v22, v231
    v_mul_f32 v23, v23, v231
    v_mul_f32 v24, v24, v231
    v_mul_f32 v25, v25, v231
    v_mul_f32 v26, v26, v231
    v_mul_f32 v27, v27, v231
    v_mul_f32 v28, v28, v231
    v_mul_f32 v29, v29, v231
    v_mul_f32 v30, v30, v231
    v_mul_f32 v31, v31, v231
    v_mul_f32 v32, v32, v231
    v_mul_f32 v33, v33, v231
    v_mul_f32 v34, v34, v231
    v_mul_f32 v35, v35, v231
    v_mul_f32 v36, v36, v231
    v_mul_f32 v37, v37, v231
    v_mul_f32 v38, v38, v231
    v_mul_f32 v39, v39, v231
    v_mul_f32 v40, v40, v231
    v_mul_f32 v41, v41, v231
    v_mul_f32 v42, v42, v231
    v_mul_f32 v43, v43, v231
    v_mul_f32 v44, v44, v231
    v_mul_f32 v45, v45, v231
    v_mul_f32 v46, v46, v231
    v_mul_f32 v47, v47, v231
    v_mul_f32 v48, v48, v231
    v_mul_f32 v49, v49, v231
    v_mul_f32 v50, v50, v231
    v_mul_f32 v51, v51, v231
    v_mul_f32 v52, v52, v231
    v_mul_f32 v53, v53, v231
    v_mul_f32 v54, v54, v231
    v_mul_f32 v55, v55, v231
    v_mul_f32 v56, v56, v231
    v_mul_f32 v57, v57, v231
    v_mul_f32 v58, v58, v231
    v_mul_f32 v59, v59, v231
    v_mul_f32 v60, v60, v231
    v_mul_f32 v61, v61, v231
    v_mul_f32 v62, v62, v231
    v_mul_f32 v63, v63, v231
    v_mul_f32 v64, v64, v231
    v_mul_f32 v65, v65, v231
    v_mul_f32 v66, v66, v231
    v_mul_f32 v67, v67, v231
    v_mul_f32 v68, v68, v231
    v_mul_f32 v69, v69, v231
    v_mul_f32 v70, v70, v231
    v_mul_f32 v71, v71, v231
    v_mul_f32 v72, v72, v231
    v_mul_f32 v73, v73, v231
    v_mul_f32 v74, v74, v231
    v_mul_f32 v75, v75, v231
    v_mul_f32 v76, v76, v231
    v_mul_f32 v77, v77, v231
    v_mul_f32 v78, v78, v231
    v_mul_f32 v79, v79, v231
    v_mul_f32 v80, v80, v231
    v_mul_f32 v81, v81, v231
    v_mul_f32 v82, v82, v231
    v_mul_f32 v83, v83, v231
    v_mul_f32 v84, v84, v231
    v_mul_f32 v85, v85, v231
    v_mul_f32 v86, v86, v231
    v_mul_f32 v87, v87, v231
    v_mul_f32 v88, v88, v231
    v_mul_f32 v89, v89, v231
    v_mul_f32 v90, v90, v231
    v_mul_f32 v91, v91, v231
    v_mul_f32 v92, v92, v231
    v_mul_f32 v93, v93, v231
    v_mul_f32 v94, v94, v231
    v_mul_f32 v95, v95, v231
L_at_nors10:
    ds_read_b64_tr_b16 v[208:209], v250 offset:24576
    ds_read_b64_tr_b16 v[210:211], v250 offset:27648
    ds_read_b64_tr_b16 v[212:213], v251 offset:24576
    ds_read_b64_tr_b16 v[214:215], v251 offset:27648
    ds_read_b64_tr_b16 v[216:217], v250 offset:24704
    ds_read_b64_tr_b16 v[218:219], v250 offset:27776
    ds_read_b64_tr_b16 v[220:221], v251 offset:24704
    ds_read_b64_tr_b16 v[222:223], v251 offset:27776
    s_waitcnt lgkmcnt(6)
    v_mfma_f32_32x32x16_bf16 v[0:15], v[208:211], v[128:131], v[0:15]
    s_nop 7
    ds_read_b64_tr_b16 v[208:209], v250 offset:24832
    ds_read_b64_tr_b16 v[210:211], v250 offset:27904
    s_waitcnt lgkmcnt(6)
    v_mfma_f32_32x32x16_bf16 v[16:31], v[212:215], v[128:131], v[16:31]
    v_max3_f32 v230, v96, v97, v98
    ds_read_b64_tr_b16 v[212:213], v251 offset:24832
    ds_read_b64_tr_b16 v[214:215], v251 offset:27904
    s_waitcnt lgkmcnt(6)
    v_mfma_f32_32x32x16_bf16 v[32:47], v[216:219], v[128:131], v[32:47]
    v_max3_f32 v230, v230, v99, v100
    ds_read_b64_tr_b16 v[216:217], v250 offset:30720
    ds_read_b64_tr_b16 v[218:219], v250 offset:33792
    s_waitcnt lgkmcnt(6)
    v_mfma_f32_32x32x16_bf16 v[48:63], v[220:223], v[128:131], v[48:63]
    v_max3_f32 v230, v230, v101, v102
    ds_read_b64_tr_b16 v[220:221], v251 offset:30720
    ds_read_b64_tr_b16 v[222:223], v251 offset:33792
    s_waitcnt lgkmcnt(6)
    v_mfma_f32_32x32x16_bf16 v[64:79], v[208:211], v[128:131], v[64:79]
    v_max3_f32 v230, v230, v103, v104
    v_max3_f32 v230, v230, v105, v106
    ds_read_b64_tr_b16 v[208:209], v250 offset:30848
    ds_read_b64_tr_b16 v[210:211], v250 offset:33920
    s_waitcnt lgkmcnt(6)
    v_mfma_f32_32x32x16_bf16 v[80:95], v[212:215], v[128:131], v[80:95]
    v_max3_f32 v230, v230, v107, v108
    ds_read_b64_tr_b16 v[212:213], v251 offset:30848
    ds_read_b64_tr_b16 v[214:215], v251 offset:33920
    s_waitcnt lgkmcnt(6)
    v_mfma_f32_32x32x16_bf16 v[0:15], v[216:219], v[132:135], v[0:15]
    v_max3_f32 v230, v230, v109, v110
    ds_read_b64_tr_b16 v[216:217], v250 offset:30976
    ds_read_b64_tr_b16 v[218:219], v250 offset:34048
    s_waitcnt lgkmcnt(6)
    v_mfma_f32_32x32x16_bf16 v[16:31], v[220:223], v[132:135], v[16:31]
    v_max3_f32 v230, v230, v111, v112
    ds_read_b64_tr_b16 v[220:221], v251 offset:30976
    ds_read_b64_tr_b16 v[222:223], v251 offset:34048
    s_waitcnt lgkmcnt(6)
    v_mfma_f32_32x32x16_bf16 v[32:47], v[208:211], v[132:135], v[32:47]
    v_max3_f32 v230, v230, v113, v114
    ds_read_b64_tr_b16 v[208:209], v250 offset:36864
    ds_read_b64_tr_b16 v[210:211], v250 offset:39936
    s_waitcnt lgkmcnt(6)
    v_mfma_f32_32x32x16_bf16 v[48:63], v[212:215], v[132:135], v[48:63]
    v_max3_f32 v230, v230, v115, v116
    v_max3_f32 v230, v230, v117, v118
    ds_read_b64_tr_b16 v[212:213], v251 offset:36864
    ds_read_b64_tr_b16 v[214:215], v251 offset:39936
    s_waitcnt lgkmcnt(6)
    v_mfma_f32_32x32x16_bf16 v[64:79], v[216:219], v[132:135], v[64:79]
    v_max3_f32 v230, v230, v119, v120
    ds_read_b64_tr_b16 v[216:217], v250 offset:36992
    ds_read_b64_tr_b16 v[218:219], v250 offset:40064
    s_waitcnt lgkmcnt(6)
    v_mfma_f32_32x32x16_bf16 v[80:95], v[220:223], v[132:135], v[80:95]
    v_max3_f32 v230, v230, v121, v122
    ds_read_b64_tr_b16 v[220:221], v251 offset:36992
    ds_read_b64_tr_b16 v[222:223], v251 offset:40064
    s_waitcnt lgkmcnt(6)
    v_mfma_f32_32x32x16_bf16 v[0:15], v[208:211], v[136:139], v[0:15]
    v_max3_f32 v230, v230, v123, v124
    ds_read_b64_tr_b16 v[208:209], v250 offset:37120
    ds_read_b64_tr_b16 v[210:211], v250 offset:40192
    s_waitcnt lgkmcnt(6)
    v_mfma_f32_32x32x16_bf16 v[16:31], v[212:215], v[136:139], v[16:31]
    v_max3_f32 v230, v230, v125, v126
    ds_read_b64_tr_b16 v[212:213], v251 offset:37120
    ds_read_b64_tr_b16 v[214:215], v251 offset:40192
    s_waitcnt lgkmcnt(6)
    v_mfma_f32_32x32x16_bf16 v[32:47], v[216:219], v[136:139], v[32:47]
    v_max_f32 v230, v230, v127
    v_mov_b32 v231, v230
    ds_read_b64_tr_b16 v[216:217], v250 offset:43008
    ds_read_b64_tr_b16 v[218:219], v250 offset:46080
    s_waitcnt lgkmcnt(6)
    v_mfma_f32_32x32x16_bf16 v[48:63], v[220:223], v[136:139], v[48:63]
    s_nop 1
    ds_read_b64_tr_b16 v[220:221], v251 offset:43008
    ds_read_b64_tr_b16 v[222:223], v251 offset:46080
    s_waitcnt lgkmcnt(6)
    v_mfma_f32_32x32x16_bf16 v[64:79], v[208:211], v[136:139], v[64:79]
    v_permlane32_swap_b32 v230, v231
    ds_read_b64_tr_b16 v[208:209], v250 offset:43136
    ds_read_b64_tr_b16 v[210:211], v250 offset:46208
    s_waitcnt lgkmcnt(6)
    v_mfma_f32_32x32x16_bf16 v[80:95], v[212:215], v[136:139], v[80:95]
    s_nop 1
    ds_read_b64_tr_b16 v[212:213], v251 offset:43136
    ds_read_b64_tr_b16 v[214:215], v251 offset:46208
    s_waitcnt lgkmcnt(6)
    v_mfma_f32_32x32x16_bf16 v[0:15], v[216:219], v[140:143], v[0:15]
    v_max3_f32 v230, v230, v231, v252
    ds_read_b64_tr_b16 v[216:217], v250 offset:43264
    ds_read_b64_tr_b16 v[218:219], v250 offset:46336
    s_waitcnt lgkmcnt(6)
    v_mfma_f32_32x32x16_bf16 v[16:31], v[220:223], v[140:143], v[16:31]
    v_sub_f32 v231, v252, v230
    v_mul_f32 v231, s27, v231
    ds_read_b64_tr_b16 v[220:221], v251 offset:43264
    ds_read_b64_tr_b16 v[222:223], v251 offset:46336
    s_waitcnt lgkmcnt(6)
    v_mfma_f32_32x32x16_bf16 v[32:47], v[208:211], v[140:143], v[32:47]
    v_exp_f32 v231, v231
    s_waitcnt lgkmcnt(4)
    v_mfma_f32_32x32x16_bf16 v[48:63], v[212:215], v[140:143], v[48:63]
    v_mov_b32 v252, v230
    s_waitcnt lgkmcnt(2)
    v_mfma_f32_32x32x16_bf16 v[64:79], v[216:219], v[140:143], v[64:79]
    v_mul_f32 v232, s27, v230
    s_waitcnt lgkmcnt(0)
    v_mfma_f32_32x32x16_bf16 v[80:95], v[220:223], v[140:143], v[80:95]
    v_mul_f32 v253, v253, v231
    v_cmp_neq_f32 vcc, 1.0, v231
    s_sub_u32 s28, s28, 1
    s_branch L_at_loop
L_at_last:
    s_waitcnt vmcnt(0)
    s_barrier
    v_fma_f32 v128, v128, s27, -v232
    v_exp_f32 v128, v128
    v_fma_f32 v129, v129, s27, -v232
    v_exp_f32 v129, v129
    v_fma_f32 v130, v130, s27, -v232
    v_exp_f32 v130, v130
    v_fma_f32 v131, v131, s27, -v232
    v_exp_f32 v131, v131
    v_fma_f32 v132, v132, s27, -v232
    v_exp_f32 v132, v132
    v_fma_f32 v133, v133, s27, -v232
    v_exp_f32 v133, v133
    v_fma_f32 v134, v134, s27, -v232
    v_exp_f32 v134, v134
    v_fma_f32 v135, v135, s27, -v232
    v_exp_f32 v135, v135
    v_fma_f32 v136, v136, s27, -v232
    v_exp_f32 v136, v136
    v_fma_f32 v137, v137, s27, -v232
    v_exp_f32 v137, v137
    v_fma_f32 v138, v138, s27, -v232
    v_exp_f32 v138, v138
    v_fma_f32 v139, v139, s27, -v232
    v_exp_f32 v139, v139
    v_fma_f32 v140, v140, s27, -v232
    v_exp_f32 v140, v140
    v_fma_f32 v141, v141, s27, -v232
    v_exp_f32 v141, v141
    v_fma_f32 v142, v142, s27, -v232
    v_exp_f32 v142, v142
    v_fma_f32 v143, v143, s27, -v232
    v_exp_f32 v143, v143
    v_fma_f32 v144, v144, s27, -v232
    v_exp_f32 v144, v144
    v_fma_f32 v145, v145, s27, -v232
    v_exp_f32 v145, v145
    v_fma_f32 v146, v146, s27, -v232
    v_exp_f32 v146, v146
    v_fma_f32 v147, v147, s27, -v232
    v_exp_f32 v147, v147
    v_fma_f32 v148, v148, s27, -v232
    v_exp_f32 v148, v148
    v_fma_f32 v149, v149, s27, -v232
    v_exp_f32 v149, v149
    v_fma_f32 v150, v150, s27, -v232
    v_exp_f32 v150, v150
    v_fma_f32 v151, v151, s27, -v232
    v_exp_f32 v151, v151
    v_fma_f32 v152, v152, s27, -v232
    v_exp_f32 v152, v152
    v_fma_f32 v153, v153, s27, -v232
    v_exp_f32 v153, v153
    v_fma_f32 v154, v154, s27, -v232
    v_exp_f32 v154, v154
    v_fma_f32 v155, v155, s27, -v232
    v_exp_f32 v155, v155
    v_fma_f32 v156, v156, s27, -v232
    v_exp_f32 v156, v156
    v_fma_f32 v157, v157, s27, -v232
    v_exp_f32 v157, v157
    v_fma_f32 v158, v158, s27, -v232
    v_exp_f32 v158, v158
    v_fma_f32 v159, v159, s27, -v232
    v_exp_f32 v159, v159
    v_add_f32 v253, v253, v128
    v_add_f32 v253, v253, v129
    v_cvt_pk_bf16_f32 v128, v128, v129
    v_add_f32 v253, v253, v130
    v_add_f32 v253, v253, v131
    v_cvt_pk_bf16_f32 v129, v130, v131
    v_add_f32 v253, v253, v132
    v_add_f32 v253, v253, v133
    v_cvt_pk_bf16_f32 v130, v132, v133
    v_add_f32 v253, v253, v134
    v_add_f32 v253, v253, v135
    v_cvt_pk_bf16_f32 v131, v134, v135
    v_add_f32 v253, v253, v136
    v_add_f32 v253, v253, v137
    v_cvt_pk_bf16_f32 v132, v136, v137
    v_add_f32 v253, v253, v138
    v_add_f32 v253, v253, v139
    v_cvt_pk_bf16_f32 v133, v138, v139
    v_add_f32 v253, v253, v140
    v_add_f32 v253, v253, v141
    v_cvt_pk_bf16_f32 v134, v140, v141
    v_add_f32 v253, v253, v142
    v_add_f32 v253, v253, v143
    v_cvt_pk_bf16_f32 v135, v142, v143
    v_add_f32 v253, v253, v144
    v_add_f32 v253, v253, v145
    v_cvt_pk_bf16_f32 v136, v144, v145
    v_add_f32 v253, v253, v146
    v_add_f32 v253, v253, v147
    v_cvt_pk_bf16_f32 v137, v146, v147
    v_add_f32 v253, v253, v148
    v_add_f32 v253, v253, v149
    v_cvt_pk_bf16_f32 v138, v148, v149
    v_add_f32 v253, v253, v150
    v_add_f32 v253, v253, v151
    v_cvt_pk_bf16_f32 v139, v150, v151
    v_add_f32 v253, v253, v152
    v_add_f32 v253, v253, v153
    v_cvt_pk_bf16_f32 v140, v152, v153
    v_add_f32 v253, v253, v154
    v_add_f32 v253, v253, v155
    v_cvt_pk_bf16_f32 v141, v154, v155
    v_add_f32 v253, v253, v156
    v_add_f32 v253, v253, v157
    v_cvt_pk_bf16_f32 v142, v156, v157
    v_add_f32 v253, v253, v158
    v_add_f32 v253, v253, v159
    v_cvt_pk_bf16_f32 v143, v158, v159
    s_nop 1
    s_cbranch_vccz L_at_nors11
    v_mul_f32 v0, v0, v231
    v_mul_f32 v1, v1, v231
    v_mul_f32 v2, v2, v231
    v_mul_f32 v3, v3, v231
    v_mul_f32 v4, v4, v231
    v_mul_f32 v5, v5, v231
    v_mul_f32 v6, v6, v231
    v_mul_f32 v7, v7, v231
    v_mul_f32 v8, v8, v231
    v_mul_f32 v9, v9, v231
    v_mul_f32 v10, v10, v231
    v_mul_f32 v11, v11, v231
    v_mul_f32 v12, v12, v231
    v_mul_f32 v13, v13, v231
    v_mul_f32 v14, v14, v231
    v_mul_f32 v15, v15, v231
    v_mul_f32 v16, v16, v231
    v_mul_f32 v17, v17, v231
    v_mul_f32 v18, v18, v231
    v_mul_f32 v19, v19, v231
    v_mul_f32 v20, v20, v231
    v_mul_f32 v21, v21, v231
    v_mul_f32 v22, v22, v231
    v_mul_f32 v23, v23, v231
    v_mul_f32 v24, v24, v231
    v_mul_f32 v25, v25, v231
    v_mul_f32 v26, v26, v231
    v_mul_f32 v27, v27, v231
    v_mul_f32 v28, v28, v231
    v_mul_f32 v29, v29, v231
    v_mul_f32 v30, v30, v231
    v_mul_f32 v31, v31, v231
    v_mul_f32 v32, v32, v231
    v_mul_f32 v33, v33, v231
    v_mul_f32 v34, v34, v231
    v_mul_f32 v35, v35, v231
    v_mul_f32 v36, v36, v231
    v_mul_f32 v37, v37, v231
    v_mul_f32 v38, v38, v231
    v_mul_f32 v39, v39, v231
    v_mul_f32 v40, v40, v231
    v_mul_f32 v41, v41, v231
    v_mul_f32 v42, v42, v231
    v_mul_f32 v43, v43, v231
    v_mul_f32 v44, v44, v231
    v_mul_f32 v45, v45, v231
    v_mul_f32 v46, v46, v231
    v_mul_f32 v47, v47, v231
    v_mul_f32 v48, v48, v231
    v_mul_f32 v49, v49, v231
    v_mul_f32 v50, v50, v231
    v_mul_f32 v51, v51, v231
    v_mul_f32 v52, v52, v231
    v_mul_f32 v53, v53, v231
    v_mul_f32 v54, v54, v231
    v_mul_f32 v55, v55, v231
    v_mul_f32 v56, v56, v231
    v_mul_f32 v57, v57, v231
    v_mul_f32 v58, v58, v231
    v_mul_f32 v59, v59, v231
    v_mul_f32 v60, v60, v231
    v_mul_f32 v61, v61, v231
    v_mul_f32 v62, v62, v231
    v_mul_f32 v63, v63, v231
    v_mul_f32 v64, v64, v231
    v_mul_f32 v65, v65, v231
    v_mul_f32 v66, v66, v231
    v_mul_f32 v67, v67, v231
    v_mul_f32 v68, v68, v231
    v_mul_f32 v69, v69, v231
    v_mul_f32 v70, v70, v231
    v_mul_f32 v71, v71, v231
    v_mul_f32 v72, v72, v231
    v_mul_f32 v73, v73, v231
    v_mul_f32 v74, v74, v231
    v_mul_f32 v75, v75, v231
    v_mul_f32 v76, v76, v231
    v_mul_f32 v77, v77, v231
    v_mul_f32 v78, v78, v231
    v_mul_f32 v79, v79, v231
    v_mul_f32 v80, v80, v231
    v_mul_f32 v81, v81, v231
    v_mul_f32 v82, v82, v231
    v_mul_f32 v83, v83, v231
    v_mul_f32 v84, v84, v231
    v_mul_f32 v85, v85, v231
    v_mul_f32 v86, v86, v231
    v_mul_f32 v87, v87, v231
    v_mul_f32 v88, v88, v231
    v_mul_f32 v89, v89, v231
    v_mul_f32 v90, v90, v231
    v_mul_f32 v91, v91, v231
    v_mul_f32 v92, v92, v231
    v_mul_f32 v93, v93, v231
    v_mul_f32 v94, v94, v231
    v_mul_f32 v95, v95, v231
L_at_nors11:
    ds_read_b64_tr_b16 v[208:209], v250 offset:24576
    ds_read_b64_tr_b16 v[210:211], v250 offset:27648
    ds_read_b64_tr_b16 v[212:213], v251 offset:24576
    ds_read_b64_tr_b16 v[214:215], v251 offset:27648
    ds_read_b64_tr_b16 v[216:217], v250 offset:24704
    ds_read_b64_tr_b16 v[218:219], v250 offset:27776
    ds_read_b64_tr_b16 v[220:221], v251 offset:24704
    ds_read_b64_tr_b16 v[222:223], v251 offset:27776
    s_waitcnt lgkmcnt(6)
    v_mfma_f32_32x32x16_bf16 v[0:15], v[208:211], v[128:131], v[0:15]
    ds_read_b64_tr_b16 v[208:209], v250 offset:24832
    ds_read_b64_tr_b16 v[210:211], v250 offset:27904
    s_waitcnt lgkmcnt(6)
    v_mfma_f32_32x32x16_bf16 v[16:31], v[212:215], v[128:131], v[16:31]
    ds_read_b64_tr_b16 v[212:213], v251 offset:24832
    ds_read_b64_tr_b16 v[214:215], v251 offset:27904
    s_waitcnt lgkmcnt(6)
    v_mfma_f32_32x32x16_bf16 v[32:47], v[216:219], v[128:131], v[32:47]
    ds_read_b64_tr_b16 v[216:217], v250 offset:30720
    ds_read_b64_tr_b16 v[218:219], v250 offset:33792
    s_waitcnt lgkmcnt(6)
    v_mfma_f32_32x32x16_bf16 v[48:63], v[220:223], v[128:131], v[48:63]
    ds_read_b64_tr_b16 v[220:221], v251 offset:30720
    ds_read_b64_tr_b16 v[222:223], v251 offset:33792
    s_waitcnt lgkmcnt(6)
    v_mfma_f32_32x32x16_bf16 v[64:79], v[208:211], v[128:131], v[64:79]
    ds_read_b64_tr_b16 v[208:209], v250 offset:30848
    ds_read_b64_tr_b16 v[210:211], v250 offset:33920
    s_waitcnt lgkmcnt(6)
    v_mfma_f32_32x32x16_bf16 v[80:95], v[212:215], v[128:131], v[80:95]
    ds_read_b64_tr_b16 v[212:213], v251 offset:30848
    ds_read_b64_tr_b16 v[214:215], v251 offset:33920
    s_waitcnt lgkmcnt(6)
    v_mfma_f32_32x32x16_bf16 v[0:15], v[216:219], v[132:135], v[0:15]
    ds_read_b64_tr_b16 v[216:217], v250 offset:30976
    ds_read_b64_tr_b16 v[218:219], v250 offset:34048
    s_waitcnt lgkmcnt(6)
    v_mfma_f32_32x32x16_bf16 v[16:31], v[220:223], v[132:135], v[16:31]
    ds_read_b64_tr_b16 v[220:221], v251 offset:30976
    ds_read_b64_tr_b16 v[222:223], v251 offset:34048
    s_waitcnt lgkmcnt(6)
    v_mfma_f32_32x32x16_bf16 v[32:47], v[208:211], v[132:135], v[32:47]
    ds_read_b64_tr_b16 v[208:209], v250 offset:36864
    ds_read_b64_tr_b16 v[210:211], v250 offset:39936
    s_waitcnt lgkmcnt(6)
    v_mfma_f32_32x32x16_bf16 v[48:63], v[212:215], v[132:135], v[48:63]
    ds_read_b64_tr_b16 v[212:213], v251 offset:36864
    ds_read_b64_tr_b16 v[214:215], v251 offset:39936
    s_waitcnt lgkmcnt(6)
    v_mfma_f32_32x32x16_bf16 v[64:79], v[216:219], v[132:135], v[64:79]
    ds_read_b64_tr_b16 v[216:217], v250 offset:36992
    ds_read_b64_tr_b16 v[218:219], v250 offset:40064
    s_waitcnt lgkmcnt(6)
    v_mfma_f32_32x32x16_bf16 v[80:95], v[220:223], v[132:135], v[80:95]
    ds_read_b64_tr_b16 v[220:221], v251 offset:36992
    ds_read_b64_tr_b16 v[222:223], v251 offset:40064
    s_waitcnt lgkmcnt(6)
    v_mfma_f32_32x32x16_bf16 v[0:15], v[208:211], v[136:139], v[0:15]
    ds_read_b64_tr_b16 v[208:209], v250 offset:37120
    ds_read_b64_tr_b16 v[210:211], v250 offset:40192
    s_waitcnt lgkmcnt(6)
    v_mfma_f32_32x32x16_bf16 v[16:31], v[212:215], v[136:139], v[16:31]
    ds_read_b64_tr_b16 v[212:213], v251 offset:37120
    ds_read_b64_tr_b16 v[214:215], v251 offset:40192
    s_waitcnt lgkmcnt(6)
    v_mfma_f32_32x32x16_bf16 v[32:47], v[216:219], v[136:139], v[32:47]
    ds_read_b64_tr_b16 v[216:217], v250 offset:43008
    ds_read_b64_tr_b16 v[218:219], v250 offset:46080
    s_waitcnt lgkmcnt(6)
    v_mfma_f32_32x32x16_bf16 v[48:63], v[220:223], v[136:139], v[48:63]
    ds_read_b64_tr_b16 v[220:221], v251 offset:43008
    ds_read_b64_tr_b16 v[222:223], v251 offset:46080
    s_waitcnt lgkmcnt(6)
    v_mfma_f32_32x32x16_bf16 v[64:79], v[208:211], v[136:139], v[64:79]
    ds_read_b64_tr_b16 v[208:209], v250 offset:43136
    ds_read_b64_tr_b16 v[210:211], v250 offset:46208
    s_waitcnt lgkmcnt(6)
    v_mfma_f32_32x32x16_bf16 v[80:95], v[212:215], v[136:139], v[80:95]
    ds_read_b64_tr_b16 v[212:213], v251 offset:43136
    ds_read_b64_tr_b16 v[214:215], v251 offset:46208
    s_waitcnt lgkmcnt(6)
    v_mfma_f32_32x32x16_bf16 v[0:15], v[216:219], v[140:143], v[0:15]
    ds_read_b64_tr_b16 v[216:217], v250 offset:43264
    ds_read_b64_tr_b16 v[218:219], v250 offset:46336
    s_waitcnt lgkmcnt(6)
    v_mfma_f32_32x32x16_bf16 v[16:31], v[220:223], v[140:143], v[16:31]
    ds_read_b64_tr_b16 v[220:221], v251 offset:43264
    ds_read_b64_tr_b16 v[222:223], v251 offset:46336
    s_waitcnt lgkmcnt(6)
    v_mfma_f32_32x32x16_bf16 v[32:47], v[208:211], v[140:143], v[32:47]
    s_waitcnt lgkmcnt(4)
    v_mfma_f32_32x32x16_bf16 v[48:63], v[212:215], v[140:143], v[48:63]
    s_waitcnt lgkmcnt(2)
    v_mfma_f32_32x32x16_bf16 v[64:79], v[216:219], v[140:143], v[64:79]
    s_waitcnt lgkmcnt(0)
    v_mfma_f32_32x32x16_bf16 v[80:95], v[220:223], v[140:143], v[80:95]
    s_nop 15
    v_mov_b32 v231, v253
    s_nop 1
    v_permlane32_swap_b32 v253, v231
    s_nop 1
    v_add_f32 v253, v253, v231
    v_rcp_f32 v253, v253
    v_lshlrev_b32 v230, 3, v227
    v_sub_u32 v229, v229, v230
    v_mul_f32 v0, v0, v253
    v_mul_f32 v1, v1, v253
    v_mul_f32 v2, v2, v253
    v_mul_f32 v3, v3, v253
    v_cvt_pk_bf16_f32 v0, v0, v1
    v_cvt_pk_bf16_f32 v1, v2, v3
    buffer_store_dwordx2 v[0:1], v229, s[20:23], 0 offen offset:0
    v_mul_f32 v4, v4, v253
    v_mul_f32 v5, v5, v253
    v_mul_f32 v6, v6, v253
    v_mul_f32 v7, v7, v253
    v_cvt_pk_bf16_f32 v4, v4, v5
    v_cvt_pk_bf16_f32 v5, v6, v7
    buffer_store_dwordx2 v[4:5], v229, s[20:23], 0 offen offset:16
    v_mul_f32 v8, v8, v253
    v_mul_f32 v9, v9, v253
    v_mul_f32 v10, v10, v253
    v_mul_f32 v11, v11, v253
    v_cvt_pk_bf16_f32 v8, v8, v9
    v_cvt_pk_bf16_f32 v9, v10, v11
    buffer_store_dwordx2 v[8:9], v229, s[20:23], 0 offen offset:32
    v_mul_f32 v12, v12, v253
    v_mul_f32 v13, v13, v253
    v_mul_f32 v14, v14, v253
    v_mul_f32 v15, v15, v253
    v_cvt_pk_bf16_f32 v12, v12, v13
    v_cvt_pk_bf16_f32 v13, v14, v15
    buffer_store_dwordx2 v[12:13], v229, s[20:23], 0 offen offset:48
    v_mul_f32 v16, v16, v253
    v_mul_f32 v17, v17, v253
    v_mul_f32 v18, v18, v253
    v_mul_f32 v19, v19, v253
    v_cvt_pk_bf16_f32 v16, v16, v17
    v_cvt_pk_bf16_f32 v17, v18, v19
    buffer_store_dwordx2 v[16:17], v229, s[20:23], 0 offen offset:64
    v_mul_f32 v20, v20, v253
    v_mul_f32 v21, v21, v253
    v_mul_f32 v22, v22, v253
    v_mul_f32 v23, v23, v253
    v_cvt_pk_bf16_f32 v20, v20, v21
    v_cvt_pk_bf16_f32 v21, v22, v23
    buffer_store_dwordx2 v[20:21], v229, s[20:23], 0 offen offset:80
    v_mul_f32 v24, v24, v253
    v_mul_f32 v25, v25, v253
    v_mul_f32 v26, v26, v253
    v_mul_f32 v27, v27, v253
    v_cvt_pk_bf16_f32 v24, v24, v25
    v_cvt_pk_bf16_f32 v25, v26, v27
    buffer_store_dwordx2 v[24:25], v229, s[20:23], 0 offen offset:96
    v_mul_f32 v28, v28, v253
    v_mul_f32 v29, v29, v253
    v_mul_f32 v30, v30, v253
    v_mul_f32 v31, v31, v253
    v_cvt_pk_bf16_f32 v28, v28, v29
    v_cvt_pk_bf16_f32 v29, v30, v31
    buffer_store_dwordx2 v[28:29], v229, s[20:23], 0 offen offset:112
    v_mul_f32 v32, v32, v253
    v_mul_f32 v33, v33, v253
    v_mul_f32 v34, v34, v253
    v_mul_f32 v35, v35, v253
    v_cvt_pk_bf16_f32 v32, v32, v33
    v_cvt_pk_bf16_f32 v33, v34, v35
    buffer_store_dwordx2 v[32:33], v229, s[20:23], 0 offen offset:128
    v_mul_f32 v36, v36, v253
    v_mul_f32 v37, v37, v253
    v_mul_f32 v38, v38, v253
    v_mul_f32 v39, v39, v253
    v_cvt_pk_bf16_f32 v36, v36, v37
    v_cvt_pk_bf16_f32 v37, v38, v39
    buffer_store_dwordx2 v[36:37], v229, s[20:23], 0 offen offset:144
    v_mul_f32 v40, v40, v253
    v_mul_f32 v41, v41, v253
    v_mul_f32 v42, v42, v253
    v_mul_f32 v43, v43, v253
    v_cvt_pk_bf16_f32 v40, v40, v41
    v_cvt_pk_bf16_f32 v41, v42, v43
    buffer_store_dwordx2 v[40:41], v229, s[20:23], 0 offen offset:160
    v_mul_f32 v44, v44, v253
    v_mul_f32 v45, v45, v253
    v_mul_f32 v46, v46, v253
    v_mul_f32 v47, v47, v253
    v_cvt_pk_bf16_f32 v44, v44, v45
    v_cvt_pk_bf16_f32 v45, v46, v47
    buffer_store_dwordx2 v[44:45], v229, s[20:23], 0 offen offset:176
    v_mul_f32 v48, v48, v253
    v_mul_f32 v49, v49, v253
    v_mul_f32 v50, v50, v253
    v_mul_f32 v51, v51, v253
    v_cvt_pk_bf16_f32 v48, v48, v49
    v_cvt_pk_bf16_f32 v49, v50, v51
    buffer_store_dwordx2 v[48:49], v229, s[20:23], 0 offen offset:192
    v_mul_f32 v52, v52, v253
    v_mul_f32 v53, v53, v253
    v_mul_f32 v54, v54, v253
    v_mul_f32 v55, v55, v253
    v_cvt_pk_bf16_f32 v52, v52, v53
    v_cvt_pk_bf16_f32 v53, v54, v55
    buffer_store_dwordx2 v[52:53], v229, s[20:23], 0 offen offset:208
    v_mul_f32 v56, v56, v253
    v_mul_f32 v57, v57, v253
    v_mul_f32 v58, v58, v253
    v_mul_f32 v59, v59, v253
    v_cvt_pk_bf16_f32 v56, v56, v57
    v_cvt_pk_bf16_f32 v57, v58, v59
    buffer_store_dwordx2 v[56:57], v229, s[20:23], 0 offen offset:224
    v_mul_f32 v60, v60, v253
    v_mul_f32 v61, v61, v253
    v_mul_f32 v62, v62, v253
    v_mul_f32 v63, v63, v253
    v_cvt_pk_bf16_f32 v60, v60, v61
    v_cvt_pk_bf16_f32 v61, v62, v63
    buffer_store_dwordx2 v[60:61], v229, s[20:23], 0 offen offset:240
    v_mul_f32 v64, v64, v253
    v_mul_f32 v65, v65, v253
    v_mul_f32 v66, v66, v253
    v_mul_f32 v67, v67, v253
    v_cvt_pk_bf16_f32 v64, v64, v65
    v_cvt_pk_bf16_f32 v65, v66, v67
    buffer_store_dwordx2 v[64:65], v229, s[20:23], 0 offen offset:256
    v_mul_f32 v68, v68, v253
    v_mul_f32 v69, v69, v253
    v_mul_f32 v70, v70, v253
    v_mul_f32 v71, v71, v253
    v_cvt_pk_bf16_f32 v68, v68, v69
    v_cvt_pk_bf16_f32 v69, v70, v71
    buffer_store_dwordx2 v[68:69], v229, s[20:23], 0 offen offset:272
    v_mul_f32 v72, v72, v253
    v_mul_f32 v73, v73, v253
    v_mul_f32 v74, v74, v253
    v_mul_f32 v75, v75, v253
    v_cvt_pk_bf16_f32 v72, v72, v73
    v_cvt_pk_bf16_f32 v73, v74, v75
    buffer_store_dwordx2 v[72:73], v229, s[20:23], 0 offen offset:288
    v_mul_f32 v76, v76, v253
    v_mul_f32 v77, v77, v253
    v_mul_f32 v78, v78, v253
    v_mul_f32 v79, v79, v253
    v_cvt_pk_bf16_f32 v76, v76, v77
    v_cvt_pk_bf16_f32 v77, v78, v79
    buffer_store_dwordx2 v[76:77], v229, s[20:23], 0 offen offset:304
    v_mul_f32 v80, v80, v253
    v_mul_f32 v81, v81, v253
    v_mul_f32 v82, v82, v253
    v_mul_f32 v83, v83, v253
    v_cvt_pk_bf16_f32 v80, v80, v81
    v_cvt_pk_bf16_f32 v81, v82, v83
    buffer_store_dwordx2 v[80:81], v229, s[20:23], 0 offen offset:320
    v_mul_f32 v84, v84, v253
    v_mul_f32 v85, v85, v253
    v_mul_f32 v86, v86, v253
    v_mul_f32 v87, v87, v253
    v_cvt_pk_bf16_f32 v84, v84, v85
    v_cvt_pk_bf16_f32 v85, v86, v87
    buffer_store_dwordx2 v[84:85], v229, s[20:23], 0 offen offset:336
    v_mul_f32 v88, v88, v253
    v_mul_f32 v89, v89, v253
    v_mul_f32 v90, v90, v253
    v_mul_f32 v91, v91, v253
    v_cvt_pk_bf16_f32 v88, v88, v89
    v_cvt_pk_bf16_f32 v89, v90, v91
    buffer_store_dwordx2 v[88:89], v229, s[20:23], 0 offen offset:352
    v_mul_f32 v92, v92, v253
    v_mul_f32 v93, v93, v253
    v_mul_f32 v94, v94, v253
    v_mul_f32 v95, v95, v253
    v_cvt_pk_bf16_f32 v92, v92, v93
    v_cvt_pk_bf16_f32 v93, v94, v95
    buffer_store_dwordx2 v[92:93], v229, s[20:23], 0 offen offset:368
L_at_end:
    s_endpgm
.globl gemm2_kernel
.p2align 8
.type gemm2_kernel,@function
gemm2_kernel:
    s_cmp_ge_u32 s2, 240
    s_cbranch_scc1 L_g2_end
    s_load_dwordx2 s[4:5], s[0:1], 32
    s_load_dwordx2 s[6:7], s[0:1], 96
    s_load_dwordx2 s[36:37], s[0:1], 64
    s_waitcnt lgkmcnt(0)
    s_mov_b32 s34, 0
    s_mov_b32 s33, s2
    s_cmp_ge_u32 s33, 40
    s_cselect_b32 s35, 40, 0
    s_cselect_b32 s42, 1, 0
    s_sub_u32 s33, s33, s35
    s_add_u32 s34, s34, s42
    s_cmp_ge_u32 s33, 40
    s_cselect_b32 s35, 40, 0
    s_cselect_b32 s42, 1, 0
    s_sub_u32 s33, s33, s35
    s_add_u32 s34, s34, s42
    s_cmp_ge_u32 s33, 40
    s_cselect_b32 s35, 40, 0
    s_cselect_b32 s42, 1, 0
    s_sub_u32 s33, s33, s35
    s_add_u32 s34, s34, s42
    s_cmp_ge_u32 s33, 40
    s_cselect_b32 s35, 40, 0
    s_cselect_b32 s42, 1, 0
    s_sub_u32 s33, s33, s35
    s_add_u32 s34, s34, s42
    s_cmp_ge_u32 s33, 40
    s_cselect_b32 s35, 40, 0
    s_cselect_b32 s42, 1, 0
    s_sub_u32 s33, s33, s35
    s_add_u32 s34, s34, s42
    s_lshr_b32 s41, s33, 3
    s_and_b32 s33, s33, 7
    s_movk_i32 s25, 1280
    s_mul_i32 s40, s34, 5242880
    s_add_u32 s40, s40, 83886080
    s_add_u32 s16, s6, s40
    s_addc_u32 s17, s7, 0
    s_mov_b32 s18, 5242880
    s_mov_b32 s19, 0x20000
    s_cmp_eq_u32 s34, 5
    s_cbranch_scc1 L_g2_h
    s_add_u32 s8, s6, 50331648
    s_addc_u32 s9, s7, 0
    s_mov_b32 s10, 25690112
    s_mov_b32 s11, 0x20000
    s_mov_b32 s12, s4
    s_mov_b32 s13, s5
    s_mov_b32 s14, 7864320
    s_mov_b32 s15, 0x20000
    s_movk_i32 s24, 12544
    s_mul_i32 s35, s34, 19*64
    s_mov_b32 s28, 19
    s_cmp_eq_u32 s34, 0
    s_cselect_b32 s28, 20, s28
    s_cselect_b32 s42, 0, 64
    s_add_u32 s35, s35, s42
    s_branch L_g2_go
L_g2_h:
    s_add_u32 s8, s6, 41943040
    s_addc_u32 s9, s7, 0
    s_mov_b32 s10, 6553600
    s_mov_b32 s11, 0x20000
    s_mov_b32 s12, s36
    s_mov_b32 s13, s37
    s_mov_b32 s14, 1966080
    s_mov_b32 s15, 0x20000
    s_movk_i32 s24, 3200
    s_mov_b32 s35, 0
    s_mov_b32 s28, 24
L_g2_go:
    s_lshl_b32 s26, s33, 8
    s_mul_i32 s26, s26, s24
    s_lshl_b32 s27, s35, 1
    s_add_u32 s26, s26, s27
    s_mul_i32 s27, s35, s25
    s_lshl_b32 s40, s41, 8
    s_add_u32 s27, s27, s40
    v_and_b32 v1, 63, v0
    v_lshrrev_b32 v2, 6, v0
    s_nop 1
    v_readfirstlane_b32 s30, v2
    v_lshrrev_b32 v3, 3, v1
    v_lshl_add_u32 v3, v2, 3, v3
    v_lshrrev_b32 v4, 1, v3
    v_xor_b32 v4, v4, v1
    v_and_b32 v4, 7, v4
    v_mul_lo_u32 v5, v3, s24
    v_lshl_add_u32 v56, v4, 4, v5
    s_lshl_b32 s31, s24, 6
    v_add_u32 v57, s31, v56
    v_add_u32 v58, s31, v57
    v_add_u32 v59, s31, v58
    v_lshrrev_b32 v3, 4, v1
    v_lshlrev_b32 v4, 2, v3
    v_xor_b32 v4, v4, v1
    v_and_b32 v4, 15, v4
    v_lshl_add_u32 v3, v2, 2, v3
    v_mul_lo_u32 v5, v3, s25
    v_lshl_add_u32 v60, v4, 4, v5
    s_lshl_b32 s31, s25, 5
    v_add_u32 v61, s31, v60
    v_and_b32 v6, 31, v1
    v_lshrrev_b32 v7, 5, v1
    v_lshrrev_b32 v8, 1, v2
    v_lshl_add_u32 v9, v8, 6, v6
    v_lshrrev_b32 v10, 1, v6
    v_and_b32 v10, 7, v10
    v_add_u32 v11, 0, v7
    v_xor_b32 v11, v11, v10
    v_lshlrev_b32 v11, 4, v11
    v_lshl_add_u32 v48, v9, 7, v11
    v_add_u32 v11, 2, v7
    v_xor_b32 v11, v11, v10
    v_lshlrev_b32 v11, 4, v11
    v_lshl_add_u32 v49, v9, 7, v11
    v_add_u32 v11, 4, v7
    v_xor_b32 v11, v11, v10
    v_lshlrev_b32 v11, 4, v11
    v_lshl_add_u32 v50, v9, 7, v11
    v_add_u32 v11, 6, v7
    v_xor_b32 v11, v11, v10
    v_lshlrev_b32 v11, 4, v11
    v_lshl_add_u32 v51, v9, 7, v11
    v_and_b32 v11, 15, v1
    v_lshrrev_b32 v11, 2, v11
    v_lshl_add_u32 v12, v7, 3, v11
    v_and_b32 v13, 1, v2
    v_lshrrev_b32 v14, 4, v1
    v_and_b32 v14, 1, v14
    v_and_b32 v15, 3, v1
    v_lshlrev_b32 v16, 3, v13
    v_add_u32 v16, 0, v16
    v_lshl_add_u32 v16, v14, 1, v16
    v_lshrrev_b32 v17, 1, v15
    v_add_u32 v16, v16, v17
    v_lshlrev_b32 v17, 2, v11
    v_xor_b32 v16, v16, v17
    v_lshlrev_b32 v16, 4, v16
    v_and_b32 v17, 1, v15
    v_lshl_add_u32 v16, v17, 3, v16
    v_lshl_add_u32 v16, v12, 8, v16
    v_add_u32 v52, 32768, v16
    v_lshlrev_b32 v16, 3, v13
    v_add_u32 v16, 4, v16
    v_lshl_add_u32 v16, v14, 1, v16
    v_lshrrev_b32 v17, 1, v15
    v_add_u32 v16, v16, v17
    v_lshlrev_b32 v17, 2, v11
    v_xor_b32 v16, v16, v17
    v_lshlrev_b32 v16, 4, v16
    v_and_b32 v17, 1, v15
    v_lshl_add_u32 v16, v17, 3, v16
    v_lshl_add_u32 v16, v12, 8, v16
    v_add_u32 v53, 32768, v16
    v_mov_b32 v64, 0
    v_mov_b32 v65, 0
    v_mov_b32 v66, 0
    v_mov_b32 v67, 0
    v_mov_b32 v68, 0
    v_mov_b32 v69, 0
    v_mov_b32 v70, 0
    v_mov_b32 v71, 0
    v_mov_b32 v72, 0
    v_mov_b32 v73, 0
    v_mov_b32 v74, 0
    v_mov_b32 v75, 0
    v_mov_b32 v76, 0
    v_mov_b32 v77, 0
    v_mov_b32 v78, 0
    v_mov_b32 v79, 0
    v_mov_b32 v80, 0
    v_mov_b32 v81, 0
    v_mov_b32 v82, 0
    v_mov_b32 v83, 0
    v_mov_b32 v84, 0
    v_mov_b32 v85, 0
    v_mov_b32 v86, 0
    v_mov_b32 v87, 0
    v_mov_b32 v88, 0
    v_mov_b32 v89, 0
    v_mov_b32 v90, 0
    v_mov_b32 v91, 0
    v_mov_b32 v92, 0
    v_mov_b32 v93, 0
    v_mov_b32 v94, 0
    v_mov_b32 v95, 0
    v_mov_b32 v96, 0
    v_mov_b32 v97, 0
    v_mov_b32 v98, 0
    v_mov_b32 v99, 0
    v_mov_b32 v100, 0
    v_mov_b32 v101, 0
    v_mov_b32 v102, 0
    v_mov_b32 v103, 0
    v_mov_b32 v104, 0
    v_mov_b32 v105, 0
    v_mov_b32 v106, 0
    v_mov_b32 v107, 0
    v_mov_b32 v108, 0
    v_mov_b32 v109, 0
    v_mov_b32 v110, 0
    v_mov_b32 v111, 0
    v_mov_b32 v112, 0
    v_mov_b32 v113, 0
    v_mov_b32 v114, 0
    v_mov_b32 v115, 0
    v_mov_b32 v116, 0
    v_mov_b32 v117, 0
    v_mov_b32 v118, 0
    v_mov_b32 v119, 0
    v_mov_b32 v120, 0
    v_mov_b32 v121, 0
    v_mov_b32 v122, 0
    v_mov_b32 v123, 0
    v_mov_b32 v124, 0
    v_mov_b32 v125, 0
    v_mov_b32 v126, 0
    v_mov_b32 v127, 0
    s_lshl_b32 s32, s30, 10
    s_mov_b32 s44, 0
    s_mov_b32 s45, 0
    s_mov_b32 s46, -98304
    s_mov_b32 s47, 49152
    s_add_u32 m0, s32, 0
    s_nop 0
    buffer_load_dwordx4 v56, s[8:11], s26 offen lds
    s_add_u32 m0, s32, 8192
    s_nop 0
    buffer_load_dwordx4 v57, s[8:11], s26 offen lds
    s_add_u32 m0, s32, 16384
    s_nop 0
    buffer_load_dwordx4 v58, s[8:11], s26 offen lds
    s_add_u32 m0, s32, 24576
    s_nop 0
    buffer_load_dwordx4 v59, s[8:11], s26 offen lds
    s_add_u32 m0, s32, 32768
    s_nop 0
    buffer_load_dwordx4 v60, s[12:15], s27 offen lds
    s_add_u32 m0, s32, 40960
    s_nop 0
    buffer_load_dwordx4 v61, s[12:15], s27 offen lds
    s_add_u32 s26, s26, 128
    s_lshl_b32 s31, s25, 6
    s_add_u32 s27, s27, s31
    s_add_u32 s32, s32, 49152
    s_add_u32 s45, s45, 1
    s_cmp_eq_u32 s45, 3
    s_cselect_b32 s31, 147456, 0
    s_cselect_b32 s45, 0, s45
    s_sub_u32 s32, s32, s31
    s_add_u32 m0, s32, 0
    s_nop 0
    buffer_load_dwordx4 v56, s[8:11], s26 offen lds
    s_add_u32 m0, s32, 8192
    s_nop 0
    buffer_load_dwordx4 v57, s[8:11], s26 offen lds
    s_add_u32 m0, s32, 16384
    s_nop 0
    buffer_load_dwordx4 v58, s[8:11], s26 offen lds
    s_add_u32 m0, s32, 24576
    s_nop 0
    buffer_load_dwordx4 v59, s[8:11], s26 offen lds
    s_add_u32 m0, s32, 32768
    s_nop 0
    buffer_load_dwordx4 v60, s[12:15], s27 offen lds
    s_add_u32 m0, s32, 40960
    s_nop 0
    buffer_load_dwordx4 v61, s[12:15], s27 offen lds
    s_add_u32 s26, s26, 128
    s_lshl_b32 s31, s25, 6
    s_add_u32 s27, s27, s31
    s_add_u32 s32, s32, 49152
    s_add_u32 s45, s45, 1
    s_cmp_eq_u32 s45, 3
    s_cselect_b32 s31, 147456, 0
    s_cselect_b32 s45, 0, s45
    s_sub_u32 s32, s32, s31
L_g2_loop:
    s_waitcnt vmcnt(6)
    s_barrier
    s_add_u32 m0, s32, 0
    s_nop 0
    buffer_load_dwordx4 v56, s[8:11], s26 offen lds
    s_add_u32 m0, s32, 8192
    s_nop 0
    buffer_load_dwordx4 v57, s[8:11], s26 offen lds
    s_add_u32 m0, s32, 16384
    s_nop 0
    buffer_load_dwordx4 v58, s[8:11], s26 offen lds
    s_add_u32 m0, s32, 24576
    s_nop 0
    buffer_load_dwordx4 v59, s[8:11], s26 offen lds
    s_add_u32 m0, s32, 32768
    s_nop 0
    buffer_load_dwordx4 v60, s[12:15], s27 offen lds
    s_add_u32 m0, s32, 40960
    s_nop 0
    buffer_load_dwordx4 v61, s[12:15], s27 offen lds
    s_add_u32 s26, s26, 128
    s_lshl_b32 s31, s25, 6
    s_add_u32 s27, s27, s31
    s_add_u32 s32, s32, 49152
    s_add_u32 s45, s45, 1
    s_cmp_eq_u32 s45, 3
    s_cselect_b32 s31, 147456, 0
    s_cselect_b32 s45, 0, s45
    s_sub_u32 s32, s32, s31
    ds_read_b128 v[16:19], v48 offset:0
    ds_read_b128 v[20:23], v48 offset:4096
    ds_read_b64_tr_b16 v[24:25], v52 offset:0
    ds_read_b64_tr_b16 v[26:27], v52 offset:1024
    ds_read_b64_tr_b16 v[28:29], v53 offset:0
    ds_read_b64_tr_b16 v[30:31], v53 offset:1024
    ds_read_b128 v[32:35], v49 offset:0
    ds_read_b128 v[36:39], v49 offset:4096
    ds_read_b64_tr_b16 v[40:41], v52 offset:4096
    ds_read_b64_tr_b16 v[42:43], v52 offset:5120
    ds_read_b64_tr_b16 v[44:45], v53 offset:4096
    ds_read_b64_tr_b16 v[46:47], v53 offset:5120
    s_waitcnt lgkmcnt(6)
    v_mfma_f32_32x32x16_bf16 v[64:79], v[24:27], v[16:19], v[64:79]
    v_mfma_f32_32x32x16_bf16 v[80:95], v[24:27], v[20:23], v[80:95]
    v_mfma_f32_32x32x16_bf16 v[96:111], v[28:31], v[16:19], v[96:111]
    v_mfma_f32_32x32x16_bf16 v[112:127], v[28:31], v[20:23], v[112:127]
    ds_read_b128 v[16:19], v50 offset:0
    ds_read_b128 v[20:23], v50 offset:4096
    ds_read_b64_tr_b16 v[24:25], v52 offset:8192
    ds_read_b64_tr_b16 v[26:27], v52 offset:9216
    ds_read_b64_tr_b16 v[28:29], v53 offset:8192
    ds_read_b64_tr_b16 v[30:31], v53 offset:9216
    s_waitcnt lgkmcnt(6)
    v_mfma_f32_32x32x16_bf16 v[64:79], v[40:43], v[32:35], v[64:79]
    v_mfma_f32_32x32x16_bf16 v[80:95], v[40:43], v[36:39], v[80:95]
    v_mfma_f32_32x32x16_bf16 v[96:111], v[44:47], v[32:35], v[96:111]
    v_mfma_f32_32x32x16_bf16 v[112:127], v[44:47], v[36:39], v[112:127]
    ds_read_b128 v[32:35], v51 offset:0
    ds_read_b128 v[36:39], v51 offset:4096
    ds_read_b64_tr_b16 v[40:41], v52 offset:12288
    ds_read_b64_tr_b16 v[42:43], v52 offset:13312
    ds_read_b64_tr_b16 v[44:45], v53 offset:12288
    ds_read_b64_tr_b16 v[46:47], v53 offset:13312
    s_waitcnt lgkmcnt(6)
    v_mfma_f32_32x32x16_bf16 v[64:79], v[24:27], v[16:19], v[64:79]
    v_mfma_f32_32x32x16_bf16 v[80:95], v[24:27], v[20:23], v[80:95]
    v_mfma_f32_32x32x16_bf16 v[96:111], v[28:31], v[16:19], v[96:111]
    v_mfma_f32_32x32x16_bf16 v[112:127], v[28:31], v[20:23], v[112:127]
    s_waitcnt lgkmcnt(0)
    s_add_u32 s44, s44, 1
    s_cmp_eq_u32 s44, 3
    s_cselect_b32 s31, s46, s47
    s_cselect_b32 s44, 0, s44
    v_add_u32 v48, s31, v48
    v_add_u32 v49, s31, v49
    v_add_u32 v50, s31, v50
    v_add_u32 v51, s31, v51
    v_add_u32 v52, s31, v52
    v_add_u32 v53, s31, v53
    v_mfma_f32_32x32x16_bf16 v[64:79], v[40:43], v[32:35], v[64:79]
    v_mfma_f32_32x32x16_bf16 v[80:95], v[40:43], v[36:39], v[80:95]
    v_mfma_f32_32x32x16_bf16 v[96:111], v[44:47], v[32:35], v[96:111]
    v_mfma_f32_32x32x16_bf16 v[112:127], v[44:47], v[36:39], v[112:127]
    s_sub_u32 s28, s28, 1
    s_cmp_lg_u32 s28, 0
    s_cbranch_scc1 L_g2_loop
    s_waitcnt vmcnt(0)
    s_nop 15
    s_lshl_b32 s33, s33, 8
    v_add_u32 v9, s33, v9
    s_movk_i32 s35, 2560
    v_mul_lo_u32 v9, v9, s35
    v_lshlrev_b32 v10, 8, v13
    v_lshl_add_u32 v10, v7, 4, v10
    s_lshl_b32 s40, s41, 9
    v_add_u32 v10, s40, v10
    v_add_u32 v9, v9, v10
    s_lshl_b32 s33, s35, 5
    v_add_u32 v8, s33, v9
    s_barrier
    v_lshlrev_b32 v11, 14, v2
    v_lshl_add_u32 v12, v6, 8, v11
    v_lshl_add_u32 v12, v7, 4, v12
    ds_write_b128 v12, v[64:67] offset:0
    ds_write_b128 v12, v[68:71] offset:32
    ds_write_b128 v12, v[72:75] offset:64
    ds_write_b128 v12, v[76:79] offset:96
    ds_write_b128 v12, v[80:83] offset:8192
    ds_write_b128 v12, v[84:87] offset:8224
    ds_write_b128 v12, v[88:91] offset:8256
    ds_write_b128 v12, v[92:95] offset:8288
    ds_write_b128 v12, v[96:99] offset:128
    ds_write_b128 v12, v[100:103] offset:160
    ds_write_b128 v12, v[104:107] offset:192
    ds_write_b128 v12, v[108:111] offset:224
    ds_write_b128 v12, v[112:115] offset:8320
    ds_write_b128 v12, v[116:119] offset:8352
    ds_write_b128 v12, v[120:123] offset:8384
    ds_write_b128 v12, v[124:127] offset:8416
    v_lshl_add_u32 v12, v1, 4, v11
    v_lshrrev_b32 v14, 4, v1
    v_lshrrev_b32 v8, 1, v2
    v_lshl_add_u32 v14, v8, 6, v14
    s_lshr_b32 s33, s33, 5
    s_and_b32 s43, s2, 7
    s_lshl_b32 s43, s43, 8
    v_add_u32 v14, s43, v14
    v_mul_lo_u32 v14, v14, s35
    v_and_b32 v15, 15, v1
    v_lshlrev_b32 v15, 4, v15
    v_lshl_add_u32 v15, v13, 8, v15
    v_add_u32 v15, s40, v15
    v_add_u32 v14, v14, v15
    s_movk_i32 s43, 10240
    s_waitcnt lgkmcnt(0)
    ds_read_b128 v[16:19], v12 offset:0
    ds_read_b128 v[20:23], v12 offset:1024
    ds_read_b128 v[24:27], v12 offset:2048
    ds_read_b128 v[28:31], v12 offset:3072
    ds_read_b128 v[32:35], v12 offset:4096
    ds_read_b128 v[36:39], v12 offset:5120
    ds_read_b128 v[40:43], v12 offset:6144
    ds_read_b128 v[44:47], v12 offset:7168
    s_waitcnt lgkmcnt(7)
    buffer_store_dwordx4 v[16:19], v14, s[16:19], 0 offen
    v_add_u32 v14, s43, v14
    s_waitcnt lgkmcnt(6)
    buffer_store_dwordx4 v[20:23], v14, s[16:19], 0 offen
    v_add_u32 v14, s43, v14
    s_waitcnt lgkmcnt(5)
    buffer_store_dwordx4 v[24:27], v14, s[16:19], 0 offen
    v_add_u32 v14, s43, v14
    s_waitcnt lgkmcnt(4)
    buffer_store_dwordx4 v[28:31], v14, s[16:19], 0 offen
    v_add_u32 v14, s43, v14
    s_waitcnt lgkmcnt(3)
    buffer_store_dwordx4 v[32:35], v14, s[16:19], 0 offen
    v_add_u32 v14, s43, v14
    s_waitcnt lgkmcnt(2)
    buffer_store_dwordx4 v[36:39], v14, s[16:19], 0 offen
    v_add_u32 v14, s43, v14
    s_waitcnt lgkmcnt(1)
    buffer_store_dwordx4 v[40:43], v14, s[16:19], 0 offen
    v_add_u32 v14, s43, v14
    s_waitcnt lgkmcnt(0)
    buffer_store_dwordx4 v[44:47], v14, s[16:19], 0 offen
    v_add_u32 v14, s43, v14
    s_nop 1
    ds_read_b128 v[16:19], v12 offset:8192
    ds_read_b128 v[20:23], v12 offset:9216
    ds_read_b128 v[24:27], v12 offset:10240
    ds_read_b128 v[28:31], v12 offset:11264
    ds_read_b128 v[32:35], v12 offset:12288
    ds_read_b128 v[36:39], v12 offset:13312
    ds_read_b128 v[40:43], v12 offset:14336
    ds_read_b128 v[44:47], v12 offset:15360
    s_waitcnt lgkmcnt(7)
    buffer_store_dwordx4 v[16:19], v14, s[16:19], 0 offen
    v_add_u32 v14, s43, v14
    s_waitcnt lgkmcnt(6)
    buffer_store_dwordx4 v[20:23], v14, s[16:19], 0 offen
    v_add_u32 v14, s43, v14
    s_waitcnt lgkmcnt(5)
    buffer_store_dwordx4 v[24:27], v14, s[16:19], 0 offen
    v_add_u32 v14, s43, v14
    s_waitcnt lgkmcnt(4)
    buffer_store_dwordx4 v[28:31], v14, s[16:19], 0 offen
    v_add_u32 v14, s43, v14
    s_waitcnt lgkmcnt(3)
    buffer_store_dwordx4 v[32:35], v14, s[16:19], 0 offen
    v_add_u32 v14, s43, v14
    s_waitcnt lgkmcnt(2)
    buffer_store_dwordx4 v[36:39], v14, s[16:19], 0 offen
    v_add_u32 v14, s43, v14
    s_waitcnt lgkmcnt(1)
    buffer_store_dwordx4 v[40:43], v14, s[16:19], 0 offen
    v_add_u32 v14, s43, v14
    s_waitcnt lgkmcnt(0)
    buffer_store_dwordx4 v[44:47], v14, s[16:19], 0 offen
    v_add_u32 v14, s43, v14
    s_nop 1
L_g2_end:
    s_endpgm
.globl final_kernel
.p2align 8
.type final_kernel,@function
final_kernel:
    s_cmp_ge_u32 s2, 1280
    s_cbranch_scc1 L_fin_end
    s_load_dwordx2 s[4:5], s[0:1], 0
    s_load_dwordx2 s[6:7], s[0:1], 96
    s_load_dwordx2 s[36:37], s[0:1], 72
    s_load_dwordx2 s[38:39], s[0:1], 80
    s_waitcnt lgkmcnt(0)
    s_mov_b32 s8, s4
    s_mov_b32 s9, s5
    s_mov_b32 s10, 2621440
    s_mov_b32 s11, 0x20000
    s_add_u32 s12, s6, 83886080
    s_addc_u32 s13, s7, 0
    s_mov_b32 s14, 31457280
    s_mov_b32 s15, 0x20000
    s_mov_b32 s16, s36
    s_mov_b32 s17, s37
    s_mov_b32 s18, 1280
    s_mov_b32 s19, 0x20000
    s_mov_b32 s20, s38
    s_mov_b32 s21, s39
    s_mov_b32 s22, 2621440
    s_mov_b32 s23, 0x20000
    s_lshl_b32 s3, s2, 8
    v_add_u32 v1, s3, v0
    v_lshlrev_b32 v2, 4, v1
    v_lshlrev_b32 v3, 3, v1
    s_mov_b32 s24, 0x0199999a
    v_mul_hi_u32 v4, v1, s24
    s_movk_i32 s25, 160
    v_mul_lo_u32 v4, v4, s25
    v_sub_u32 v4, v1, v4
    v_lshlrev_b32 v4, 3, v4
    buffer_load_dwordx4 v[8:11], v2, s[12:15], 0 offen
    s_mov_b32 s26, 5242880
    buffer_load_dwordx4 v[12:15], v2, s[12:15], s26 offen
    s_mov_b32 s26, 10485760
    buffer_load_dwordx4 v[16:19], v2, s[12:15], s26 offen
    s_mov_b32 s26, 15728640
    buffer_load_dwordx4 v[32:35], v2, s[12:15], s26 offen
    s_mov_b32 s26, 20971520
    buffer_load_dwordx4 v[36:39], v2, s[12:15], s26 offen
    s_mov_b32 s26, 26214400
    buffer_load_dwordx4 v[20:23], v2, s[12:15], s26 offen
    buffer_load_dwordx2 v[24:25], v3, s[8:11], 0 offen
    buffer_load_dwordx2 v[26:27], v4, s[16:19], 0 offen
    s_mov_b32 s29, 0xbfb8aa3b
    s_waitcnt vmcnt(0)
    v_add_f32 v8, v8, v12
    v_add_f32 v8, v8, v16
    v_add_f32 v8, v8, v32
    v_add_f32 v8, v8, v36
    v_cvt_pk_bf16_f32 v8, v8, v8
    v_lshlrev_b32 v8, 16, v8
    v_cvt_pk_bf16_f32 v20, v20, v20
    v_lshlrev_b32 v20, 16, v20
    v_lshlrev_b32 v28, 16, v26
    v_lshlrev_b32 v29, 16, v24
    v_add_f32 v20, v20, v28
    v_cvt_pk_bf16_f32 v20, v20, v20
    v_lshlrev_b32 v20, 16, v20
    v_mul_f32 v30, s29, v20
    v_exp_f32 v30, v30
    s_nop 0
    v_add_f32 v30, 1.0, v30
    v_rcp_f32 v30, v30
    s_nop 0
    v_mul_f32 v20, v20, v30
    v_cvt_pk_bf16_f32 v20, v20, v20
    v_lshlrev_b32 v20, 16, v20
    v_mul_f32 v8, v8, v20
    v_cvt_pk_bf16_f32 v8, v8, v8
    v_lshlrev_b32 v8, 16, v8
    v_add_f32 v8, v8, v29
    v_add_f32 v9, v9, v13
    v_add_f32 v9, v9, v17
    v_add_f32 v9, v9, v33
    v_add_f32 v9, v9, v37
    v_cvt_pk_bf16_f32 v9, v9, v9
    v_lshlrev_b32 v9, 16, v9
    v_cvt_pk_bf16_f32 v21, v21, v21
    v_lshlrev_b32 v21, 16, v21
    v_and_b32 v28, 0xffff0000, v26
    v_and_b32 v29, 0xffff0000, v24
    v_add_f32 v21, v21, v28
    v_cvt_pk_bf16_f32 v21, v21, v21
    v_lshlrev_b32 v21, 16, v21
    v_mul_f32 v30, s29, v21
    v_exp_f32 v30, v30
    s_nop 0
    v_add_f32 v30, 1.0, v30
    v_rcp_f32 v30, v30
    s_nop 0
    v_mul_f32 v21, v21, v30
    v_cvt_pk_bf16_f32 v21, v21, v21
    v_lshlrev_b32 v21, 16, v21
    v_mul_f32 v9, v9, v21
    v_cvt_pk_bf16_f32 v9, v9, v9
    v_lshlrev_b32 v9, 16, v9
    v_add_f32 v9, v9, v29
    v_add_f32 v10, v10, v14
    v_add_f32 v10, v10, v18
    v_add_f32 v10, v10, v34
    v_add_f32 v10, v10, v38
    v_cvt_pk_bf16_f32 v10, v10, v10
    v_lshlrev_b32 v10, 16, v10
    v_cvt_pk_bf16_f32 v22, v22, v22
    v_lshlrev_b32 v22, 16, v22
    v_lshlrev_b32 v28, 16, v27
    v_lshlrev_b32 v29, 16, v25
    v_add_f32 v22, v22, v28
    v_cvt_pk_bf16_f32 v22, v22, v22
    v_lshlrev_b32 v22, 16, v22
    v_mul_f32 v30, s29, v22
    v_exp_f32 v30, v30
    s_nop 0
    v_add_f32 v30, 1.0, v30
    v_rcp_f32 v30, v30
    s_nop 0
    v_mul_f32 v22, v22, v30
    v_cvt_pk_bf16_f32 v22, v22, v22
    v_lshlrev_b32 v22, 16, v22
    v_mul_f32 v10, v10, v22
    v_cvt_pk_bf16_f32 v10, v10, v10
    v_lshlrev_b32 v10, 16, v10
    v_add_f32 v10, v10, v29
    v_add_f32 v11, v11, v15
    v_add_f32 v11, v11, v19
    v_add_f32 v11, v11, v35
    v_add_f32 v11, v11, v39
    v_cvt_pk_bf16_f32 v11, v11, v11
    v_lshlrev_b32 v11, 16, v11
    v_cvt_pk_bf16_f32 v23, v23, v23
    v_lshlrev_b32 v23, 16, v23
    v_and_b32 v28, 0xffff0000, v27
    v_and_b32 v29, 0xffff0000, v25
    v_add_f32 v23, v23, v28
    v_cvt_pk_bf16_f32 v23, v23, v23
    v_lshlrev_b32 v23, 16, v23
    v_mul_f32 v30, s29, v23
    v_exp_f32 v30, v30
    s_nop 0
    v_add_f32 v30, 1.0, v30
    v_rcp_f32 v30, v30
    s_nop 0
    v_mul_f32 v23, v23, v30
    v_cvt_pk_bf16_f32 v23, v23, v23
    v_lshlrev_b32 v23, 16, v23
    v_mul_f32 v11, v11, v23
    v_cvt_pk_bf16_f32 v11, v11, v11
    v_lshlrev_b32 v11, 16, v11
    v_add_f32 v11, v11, v29
    v_cvt_pk_bf16_f32 v12, v8, v9
    v_cvt_pk_bf16_f32 v13, v10, v11
    buffer_store_dwordx2 v[12:13], v3, s[20:23], 0 offen
L_fin_end:
    s_endpgm
.section .rodata,"a"
.p2align 6
.amdhsa_kernel ln_kernel
  .amdhsa_next_free_vgpr 64
  .amdhsa_next_free_sgpr 32
  .amdhsa_accum_offset 64
  .amdhsa_group_segment_fixed_size 0
  .amdhsa_kernarg_size 104
  .amdhsa_user_sgpr_count 2
  .amdhsa_user_sgpr_kernarg_segment_ptr 1
  .amdhsa_system_sgpr_workgroup_id_x 1
.end_amdhsa_kernel
.p2align 6
.amdhsa_kernel gemm1_kernel
  .amdhsa_next_free_vgpr 128
  .amdhsa_next_free_sgpr 96
  .amdhsa_accum_offset 128
  .amdhsa_group_segment_fixed_size 0
  .amdhsa_kernarg_size 104
  .amdhsa_user_sgpr_count 2
  .amdhsa_user_sgpr_kernarg_segment_ptr 1
  .amdhsa_system_sgpr_workgroup_id_x 1
.end_amdhsa_kernel
.p2align 6
.amdhsa_kernel attn_kernel
  .amdhsa_next_free_vgpr 256
  .amdhsa_next_free_sgpr 96
  .amdhsa_accum_offset 256
  .amdhsa_group_segment_fixed_size 0
  .amdhsa_kernarg_size 104
  .amdhsa_user_sgpr_count 2
  .amdhsa_user_sgpr_kernarg_segment_ptr 1
  .amdhsa_system_sgpr_workgroup_id_x 1
.end_amdhsa_kernel
.p2align 6
.amdhsa_kernel gemm2_kernel
  .amdhsa_next_free_vgpr 128
  .amdhsa_next_free_sgpr 96
  .amdhsa_accum_offset 128
  .amdhsa_group_segment_fixed_size 0
  .amdhsa_kernarg_size 104
  .amdhsa_user_sgpr_count 2
  .amdhsa_user_sgpr_kernarg_segment_ptr 1
  .amdhsa_system_sgpr_workgroup_id_x 1
.end_amdhsa_kernel
.p2align 6
.amdhsa_kernel final_kernel
  .amdhsa_next_free_vgpr 40
  .amdhsa_next_free_sgpr 96
  .amdhsa_accum_offset 40
  .amdhsa_group_segment_fixed_size 0
  .amdhsa_kernarg_size 104
  .amdhsa_user_sgpr_count 2
  .amdhsa_user_sgpr_kernarg_segment_ptr 1
  .amdhsa_system_sgpr_workgroup_id_x 1
.end_amdhsa_kernel
```
